```python
import torch

def _softmax(x, axis=-1):
    return torch.softmax(x, dim=axis)
def _gelu(x):
    return torch.nn.functional.gelu(x, approximate="tanh")
def _silu(x):
    return torch.nn.functional.silu(x)
def _sigmoid(x):
    return torch.sigmoid(x)
def _layernorm(x, axis=-1, eps=1e-5):
    m = x.mean(dim=axis, keepdim=True)
    v = x.var(dim=axis, keepdim=True, unbiased=False)
    return (x - m) / torch.sqrt(v + eps)
def _scatter_add(tgt, idx, src, axis=0):
    return tgt.clone().index_add_(axis, idx, src)
def _segment_sum(src, seg, n):
    out = torch.zeros((n,) + src.shape[1:], dtype=src.dtype)
    return out.index_add_(0, seg, src)
def _pad(x, pw):
    flat = tuple(v for pair in reversed(pw) for v in pair)
    return torch.nn.functional.pad(x, flat)

kernel_name = 'concat_heads__mha_block_cached__gqa_block_cached__near_ridge'

def setup_inputs():

    _w = (lambda a: (lambda t: t.to(torch.bfloat16) if t.is_floating_point() else t)(torch.as_tensor(a)))
    def _A_setup():
        B, Sq, D = 8, 160, 1024
        H, Sk, Dh = 32, 1024, 128
        return {
            "x": _w((lambda *s: torch.randn(*s, dtype=torch.bfloat16) * 0.8)(B, Sq, D)),
            "k_cache": _w((lambda *s: torch.randn(*s, dtype=torch.bfloat16) * 0.8)(B, H, Sk, Dh)),
            "v_cache": _w((lambda *s: torch.randn(*s, dtype=torch.bfloat16) * 0.05)(B, H, Sk, Dh)),
            "wq": _w((lambda *s: torch.randn(*s, dtype=torch.bfloat16) * 0.8)(D, H * Dh) * (D ** -0.5)),
            "wo": _w((lambda *s: torch.randn(*s, dtype=torch.bfloat16) * 0.05)(H * Dh, D) * ((H * Dh) ** -0.5)),
        }
    _A_in = _A_setup()

    def _B_setup():
        B, Sq, D = 8, 160, 1024
        Hq, Hkv, Sk, Dh = 32, 32, 1024, 128
        assert Hq % Hkv == 0, (Hq, Hkv)
        return {
            "x": _w((lambda *s: torch.randn(*s, dtype=torch.bfloat16) * 0.8)(B, Sq, D)),
            "k_cache": _w((lambda *s: torch.randn(*s, dtype=torch.bfloat16) * 0.8)(B, Hkv, Sk, Dh)),
            "v_cache": _w((lambda *s: torch.randn(*s, dtype=torch.bfloat16) * 0.05)(B, Hkv, Sk, Dh)),
            "wq": _w((lambda *s: torch.randn(*s, dtype=torch.bfloat16) * 0.8)(D, Hq * Dh) * (D ** -0.5)),
            "wo": _w((lambda *s: torch.randn(*s, dtype=torch.bfloat16) * 0.05)(Hq * Dh, D) * ((Hq * Dh) ** -0.5)),
        }
    _B_in = _B_setup()

    return {
        "A_x": _A_in["x"],
        "A_k_cache": _A_in["k_cache"],
        "A_v_cache": _A_in["v_cache"],
        "A_wq": _A_in["wq"],
        "A_wo": _A_in["wo"],
        "B_x": _B_in["x"],
        "B_k_cache": _B_in["k_cache"],
        "B_v_cache": _B_in["v_cache"],
        "B_wq": _B_in["wq"],
        "B_wo": _B_in["wo"],
    }

def reference(A_x, A_k_cache, A_v_cache, A_wq, A_wo, B_x, B_k_cache, B_v_cache, B_wq, B_wo):
    def _A_ref(x, k_cache, v_cache, wq, wo):
        B, Sq, D = x.shape
        H, Dh = 32, 128
        q = (lambda x, *d: x.permute(*d))((x @ wq).reshape(B, Sq, H, Dh), 0, 2, 1, 3)
        scores = torch.einsum("bhqd,bhkd->bhqk", q, k_cache) * (Dh ** -0.5)
        p = _softmax(scores, axis=-1)
        o = torch.einsum("bhqk,bhkd->bhqd", p, v_cache)
        return (lambda x, *d: x.permute(*d))(o, 0, 2, 1, 3).reshape(B, Sq, H * Dh) @ wo

    def _B_ref(x, k_cache, v_cache, wq, wo):
        B, Sq, D = x.shape
        Hq, Dh = 32, 128
        Hkv = k_cache.shape[1]
        rep = Hq // Hkv
        q = (lambda x, *d: x.permute(*d))((x @ wq).reshape(B, Sq, Hq, Dh), 0, 2, 1, 3)
        k = (lambda x, n, axis: torch.repeat_interleave(x, n, dim=axis))(k_cache, rep, axis=1)
        v = (lambda x, n, axis: torch.repeat_interleave(x, n, dim=axis))(v_cache, rep, axis=1)
        scores = torch.einsum("bhqd,bhkd->bhqk", q, k) * (Dh ** -0.5)
        p = _softmax(scores, axis=-1)
        o = torch.einsum("bhqk,bhkd->bhqd", p, v)
        return (lambda x, *d: x.permute(*d))(o, 0, 2, 1, 3).reshape(B, Sq, Hq * Dh) @ wo

    a = _A_ref(A_x, A_k_cache, A_v_cache, A_wq, A_wo)
    b = _B_ref(B_x, B_k_cache, B_v_cache, B_wq, B_wo)
    return torch.concatenate([a, b], axis=-1)
```

```asm
; @launch grid=(256,1,1) block=(256,1,1) lds=163840
.amdgcn_target "amdgcn-amd-amdhsa--gfx950"
.text
.globl concat_heads__mha_block_cached__gqa_block_cached__near_ridge_kernel
.p2align 8
.type concat_heads__mha_block_cached__gqa_block_cached__near_ridge_kernel,@function
concat_heads__mha_block_cached__gqa_block_cached__near_ridge_kernel:
s_cmp_ge_u32 s2, 256
s_cbranch_scc1 L_end
s_load_dwordx16 s[32:47], s[0:1], 0
s_load_dwordx4 s[48:51], s[0:1], 64
s_load_dwordx4 s[52:55], s[0:1], 80
s_load_dwordx2 s[16:17], s[0:1], 96
s_getpc_b64 s[68:69]
L_pc:
s_mov_b32 s70, L_code_end-L_pc
s_mov_b32 s71, 0x20000
v_lshrrev_b32 v3, 4, v0
s_lshr_b32 s24, s2, 3
s_lshl_b32 s28, s24, 11
v_lshlrev_b32 v3, 7, v3
buffer_load_dword a150, v3, s[68:71], s28 offen
v_lshrrev_b32 v1, 6, v0
v_and_b32 v2, 63, v0
v_readfirstlane_b32 s20, v1
s_bfe_u32 s25, s2, 65538
s_bfe_u32 s23, s2, 65537
s_lshr_b32 s27, s24, 2
s_and_b32 s63, s24, 3
s_lshr_b32 s21, s20, 1
s_and_b32 s22, s20, 1
s_lshl_b32 s26, s23, 2
s_add_u32 s26, s26, s63
s_add_u32 s64, s26, s27
s_mul_i32 s28, s20, 40
v_lshrrev_b32 v1, 3, v2
v_add_u32 v1, s28, v1
v_lshrrev_b32 v3, 1, v1
v_xor_b32 v3, v3, v2
v_and_b32 v3, 7, v3
v_lshlrev_b32 v3, 4, v3
v_lshl_add_u32 v14, v1, 11, v3
v_xor_b32 v1, 64, v14
v_add_u32 v15, 15360, v1
v_add_u32 v16, 30720, v14
v_add_u32 v17, 46080, v1
v_add_u32 v18, 65536, v14
v_and_b32 v52, 15, v2
v_lshrrev_b32 v53, 4, v2
s_lshl_b32 s28, s20, 4
v_add_u32 v1, s28, v53
v_lshlrev_b32 v3, 1, v53
v_xor_b32 v3, v3, v52
v_lshrrev_b32 v12, 3, v3
v_lshlrev_b32 v12, 8, v12
v_and_b32 v3, 7, v3
v_lshl_add_u32 v3, v3, 4, v12
v_lshl_add_u32 v19, v1, 13, v3
v_xor_b32 v1, 256, v19
v_add_u32 v20, 31744, v19
v_add_u32 v21, 63488, v1
v_add_u32 v22, 95232, v1
s_mul_i32 s60, s20, 5120
s_add_u32 s60, s60, 57344
s_lshl_b32 s61, s20, 12
s_add_u32 s61, s61, 98304
s_mul_i32 s28, s27, 327680
s_mov_b32 s6, 327680
s_mov_b32 s7, 0x20000
s_mov_b32 s10, 8388608
s_mov_b32 s11, 0x20000
s_mov_b32 s65, 0
s_and_b32 s3, s2, 1
s_xor_b32 s29, s3, s23
s_lshl_b32 s29, s29, 1
s_add_u32 s23, s29, s3
s_lshl_b32 s29, s23, 2
s_add_u32 s63, s63, s29
s_lshl_b32 s63, s63, 1
s_cmp_eq_u32 s25, 1
s_waitcnt lgkmcnt(0)
s_cselect_b32 s4, s42, s32
s_cselect_b32 s5, s43, s33
s_cselect_b32 s8, s48, s38
s_cselect_b32 s9, s49, s39
s_cselect_b32 s56, s44, s34
s_cselect_b32 s57, s45, s35
s_cselect_b32 s58, s46, s36
s_cselect_b32 s59, s47, s37
s_cselect_b32 s32, s50, s40
s_cselect_b32 s33, s51, s41
s_add_u32 s4, s4, s28
s_addc_u32 s5, s5, 0
s_lshl_b32 s37, s63, 8
s_add_u32 s28, s65, s64
s_and_b32 s28, s28, 1
s_andn2_b32 s29, s65, 1
s_or_b32 s28, s28, s29
s_lshl_b32 s30, s28, 19
s_add_u32 s30, s30, s37
s_lshl_b32 s29, s28, 7
s_add_u32 s65, s65, 1
s_add_u32 m0, s60, 0
s_nop 0
buffer_load_dwordx4 v14, s[4:7], s29 offen offset:0 lds
buffer_load_dwordx4 v15, s[4:7], s29 offen offset:1024 lds
buffer_load_dwordx4 v16, s[4:7], s29 offen offset:2048 lds
buffer_load_dwordx4 v17, s[4:7], s29 offen offset:3072 lds
s_add_u32 m0, s60, 4096
s_nop 0
buffer_load_dwordx4 v18, s[4:7], s29 offen lds
s_add_u32 m0, s61, 0
s_nop 0
buffer_load_dwordx4 v19, s[8:11], s30 offen offset:0 lds
buffer_load_dwordx4 v20, s[8:11], s30 offen offset:1024 lds
buffer_load_dwordx4 v21, s[8:11], s30 offen offset:2048 lds
buffer_load_dwordx4 v22, s[8:11], s30 offen offset:3072 lds
s_add_u32 s30, s30, 128
s_add_u32 m0, s61, 16384
s_nop 0
buffer_load_dwordx4 v19, s[8:11], s30 offen offset:0 lds
buffer_load_dwordx4 v20, s[8:11], s30 offen offset:1024 lds
buffer_load_dwordx4 v21, s[8:11], s30 offen offset:2048 lds
buffer_load_dwordx4 v22, s[8:11], s30 offen offset:3072 lds
s_mov_b32 s34, s3
s_mov_b32 s18, 41943040
s_mov_b32 s19, 0x20000
s_lshl_b32 s39, s2, 7
s_add_u32 s39, s39, 25165824
v_lshlrev_b32 v51, 4, v2
s_cmp_lg_u32 s20, 0
s_cbranch_scc1 L_init_skip
v_and_b32 v3, 31, v2
v_cmp_eq_u32 vcc, s23, v3
v_lshlrev_b32 v3, 2, v3
s_nop 0
v_cndmask_b32 v12, 0, 1, vcc
buffer_store_dword v12, v3, s[16:19], s39 offen sc1
L_init_skip:
v_lshrrev_b32 v54, 2, v52
v_and_b32 v55, 3, v2
s_mul_i32 s28, s22, 80
v_add_u32 v1, s28, v52
v_lshlrev_b32 v1, 7, v1
v_lshrrev_b32 v3, 1, v52
v_xor_b32 v3, v3, v53
v_lshlrev_b32 v3, 4, v3
v_add_u32 v1, 57344, v1
v_add_u32 v4, v1, v3
v_xor_b32 v5, 64, v4
v_and_b32 v1, 1, v53
v_lshl_or_b32 v1, v1, 2, v54
v_lshl_add_u32 v3, v53, 3, v54
v_lshlrev_b32 v3, 8, v3
v_lshl_add_u32 v3, v55, 3, v3
v_lshl_add_u32 v3, v1, 5, v3
s_lshl_b32 s28, s21, 7
s_add_u32 s28, s28, 98304
v_xor_b32 v23, s28, v3
v_xor_b32 v24, 32, v23
v_xor_b32 v25, 64, v23
v_xor_b32 v26, 96, v23
s_lshl_b32 s28, s21, 7
s_lshl_b32 s29, s34, 6
s_add_u32 s35, s28, s29
v_xor_b32 v8, s35, v3
v_xor_b32 v9, 32, v8
v_xor_b32 v10, 64, v8
v_xor_b32 v11, 96, v8
v_lshl_add_u32 v3, v53, 2, v54
v_lshlrev_b32 v3, 8, v3
v_lshl_add_u32 v3, v55, 3, v3
s_lshl_b32 s28, s21, 14
s_add_u32 s29, s28, 8192
v_add_u32 v3, s29, v3
v_lshl_add_u32 v31, v1, 5, v3
v_xor_b32 v32, 32, v31
v_xor_b32 v33, 64, v31
v_xor_b32 v34, 96, v31
v_xor_b32 v35, 128, v31
v_xor_b32 v36, 160, v31
v_xor_b32 v37, 192, v31
v_xor_b32 v38, 224, v31
v_add_u32 v39, 0x10000, v31
v_add_u32 v40, 0x10000, v32
v_add_u32 v41, 0x10000, v33
v_add_u32 v42, 0x10000, v34
v_add_u32 v43, 0x10000, v35
v_add_u32 v44, 0x10000, v36
v_add_u32 v45, 0x10000, v37
v_add_u32 v46, 0x10000, v38
s_cmp_eq_u32 s22, 1
s_cselect_b32 s12, s58, s56
s_cselect_b32 s13, s59, s57
s_cselect_b64 s[66:67], -1, 0
s_add_u32 s63, s63, s21
s_lshl_b32 s28, s27, 5
s_add_u32 s28, s28, s63
s_lshl_b32 s28, s28, 18
s_add_u32 s12, s12, s28
s_addc_u32 s13, s13, 0
s_mov_b32 s14, 0x40000
s_mov_b32 s15, 0x20000
s_mov_b32 s29, s24
s_mov_b32 s3, 0
s_bfe_u32 s28, s29, 65536
s_lshl_b32 s28, s28, 8
s_or_b32 s3, s3, s28
s_bfe_u32 s28, s29, 65537
s_lshl_b32 s28, s28, 9
s_or_b32 s3, s3, s28
s_bfe_u32 s28, s29, 65538
s_lshl_b32 s28, s28, 10
s_or_b32 s3, s3, s28
s_bfe_u32 s28, s29, 65539
s_lshl_b32 s28, s28, 11
s_or_b32 s3, s3, s28
s_bfe_u32 s28, s29, 65540
s_lshl_b32 s28, s28, 17
s_or_b32 s3, s3, s28
s_lshl_b32 s62, s20, 13
v_add_u32 v1, 0, v53
v_add_u32 v3, 0, v53
v_lshlrev_b32 v3, 1, v3
v_cndmask_b32 v1, v1, v3, s[66:67]
v_xor_b32 v1, v1, v52
v_lshlrev_b32 v1, 4, v1
v_and_b32 v3, 1, v53
v_lshl_add_u32 v1, v3, 12, v1
v_lshrrev_b32 v3, 1, v53
v_lshl_add_u32 v1, v3, 13, v1
v_add_u32 v47, 0, v1
v_add_u32 v1, 4, v53
v_add_u32 v3, 4, v53
v_lshlrev_b32 v3, 1, v3
v_cndmask_b32 v1, v1, v3, s[66:67]
v_xor_b32 v1, v1, v52
v_lshlrev_b32 v1, 4, v1
v_and_b32 v3, 1, v53
v_lshl_add_u32 v1, v3, 12, v1
v_lshrrev_b32 v3, 1, v53
v_lshl_add_u32 v1, v3, 13, v1
v_add_u32 v48, 15360, v1
v_add_u32 v1, 8, v53
v_add_u32 v3, 0, v53
v_lshlrev_b32 v3, 1, v3
v_cndmask_b32 v1, v1, v3, s[66:67]
v_xor_b32 v1, v1, v52
v_lshlrev_b32 v1, 4, v1
v_and_b32 v3, 1, v53
v_lshl_add_u32 v1, v3, 12, v1
v_lshrrev_b32 v3, 1, v53
v_lshl_add_u32 v1, v3, 13, v1
v_add_u32 v49, 30720, v1
v_add_u32 v1, 12, v53
v_add_u32 v3, 4, v53
v_lshlrev_b32 v3, 1, v3
v_cndmask_b32 v1, v1, v3, s[66:67]
v_xor_b32 v1, v1, v52
v_lshlrev_b32 v1, 4, v1
v_and_b32 v3, 1, v53
v_lshl_add_u32 v1, v3, 12, v1
v_lshrrev_b32 v3, 1, v53
v_lshl_add_u32 v1, v3, 13, v1
v_add_u32 v50, 46080, v1
s_mov_b32 s66, 1040356334
s_mov_b32 s67, s66
s_lshl_b32 s40, s25, 3
s_add_u32 s40, s40, s27
s_mov_b32 s68, s54
s_mov_b32 s69, s55
s_mov_b32 s70, 256
s_mov_b32 s71, 0x20000
s_mov_b32 s36, 0
s_lshr_b32 s38, s24, 3
s_lshl_b32 s38, s38, 1
s_add_u32 s38, s38, 5
s_cmp_lg_u32 s20, 0
s_cselect_b32 s38, 15, s38
s_mov_b32 s28, 0x2000
buffer_load_dword a146, off, s[12:15], s28 nt
v_mov_b32 v96, 0
v_mov_b32 v97, 0
v_mov_b32 v98, 0
v_mov_b32 v99, 0
v_mov_b32 v100, 0
v_mov_b32 v101, 0
v_mov_b32 v102, 0
v_mov_b32 v103, 0
v_mov_b32 v104, 0
v_mov_b32 v105, 0
v_mov_b32 v106, 0
v_mov_b32 v107, 0
v_mov_b32 v108, 0
v_mov_b32 v109, 0
v_mov_b32 v110, 0
v_mov_b32 v111, 0
v_mov_b32 v112, 0
v_mov_b32 v113, 0
v_mov_b32 v114, 0
v_mov_b32 v115, 0
v_mov_b32 v116, 0
v_mov_b32 v117, 0
v_mov_b32 v118, 0
v_mov_b32 v119, 0
v_mov_b32 v120, 0
v_mov_b32 v121, 0
v_mov_b32 v122, 0
v_mov_b32 v123, 0
v_mov_b32 v124, 0
v_mov_b32 v125, 0
v_mov_b32 v126, 0
v_mov_b32 v127, 0
v_mov_b32 v128, 0
v_mov_b32 v129, 0
v_mov_b32 v130, 0
v_mov_b32 v131, 0
v_mov_b32 v132, 0
v_mov_b32 v133, 0
v_mov_b32 v134, 0
v_mov_b32 v135, 0
v_mov_b32 v136, 0
v_mov_b32 v137, 0
v_mov_b32 v138, 0
v_mov_b32 v139, 0
v_mov_b32 v140, 0
v_mov_b32 v141, 0
v_mov_b32 v142, 0
v_mov_b32 v143, 0
v_mov_b32 v144, 0
v_mov_b32 v145, 0
v_mov_b32 v146, 0
v_mov_b32 v147, 0
v_mov_b32 v148, 0
v_mov_b32 v149, 0
v_mov_b32 v150, 0
v_mov_b32 v151, 0
v_mov_b32 v152, 0
v_mov_b32 v153, 0
v_mov_b32 v154, 0
v_mov_b32 v155, 0
v_mov_b32 v156, 0
v_mov_b32 v157, 0
v_mov_b32 v158, 0
v_mov_b32 v159, 0
v_mov_b32 v160, 0
v_mov_b32 v161, 0
v_mov_b32 v162, 0
v_mov_b32 v163, 0
v_mov_b32 v164, 0
v_mov_b32 v165, 0
v_mov_b32 v166, 0
v_mov_b32 v167, 0
v_mov_b32 v168, 0
v_mov_b32 v169, 0
v_mov_b32 v170, 0
v_mov_b32 v171, 0
v_mov_b32 v172, 0
v_mov_b32 v173, 0
v_mov_b32 v174, 0
v_mov_b32 v175, 0
v_mov_b32 v176, 0
v_mov_b32 v177, 0
v_mov_b32 v178, 0
v_mov_b32 v179, 0
v_mov_b32 v180, 0
v_mov_b32 v181, 0
v_mov_b32 v182, 0
v_mov_b32 v183, 0
v_mov_b32 v184, 0
v_mov_b32 v185, 0
v_mov_b32 v186, 0
v_mov_b32 v187, 0
v_mov_b32 v188, 0
v_mov_b32 v189, 0
v_mov_b32 v190, 0
v_mov_b32 v191, 0
v_mov_b32 v192, 0
v_mov_b32 v193, 0
v_mov_b32 v194, 0
v_mov_b32 v195, 0
v_mov_b32 v196, 0
v_mov_b32 v197, 0
v_mov_b32 v198, 0
v_mov_b32 v199, 0
v_mov_b32 v200, 0
v_mov_b32 v201, 0
v_mov_b32 v202, 0
v_mov_b32 v203, 0
v_mov_b32 v204, 0
v_mov_b32 v205, 0
v_mov_b32 v206, 0
v_mov_b32 v207, 0
v_mov_b32 v208, 0
v_mov_b32 v209, 0
v_mov_b32 v210, 0
v_mov_b32 v211, 0
v_mov_b32 v212, 0
v_mov_b32 v213, 0
v_mov_b32 v214, 0
v_mov_b32 v215, 0
v_mov_b32 v216, 0
v_mov_b32 v217, 0
v_mov_b32 v218, 0
v_mov_b32 v219, 0
v_mov_b32 v220, 0
v_mov_b32 v221, 0
v_mov_b32 v222, 0
v_mov_b32 v223, 0
v_mov_b32 v224, 0
v_mov_b32 v225, 0
v_mov_b32 v226, 0
v_mov_b32 v227, 0
v_mov_b32 v228, 0
v_mov_b32 v229, 0
v_mov_b32 v230, 0
v_mov_b32 v231, 0
v_mov_b32 v232, 0
v_mov_b32 v233, 0
v_mov_b32 v234, 0
v_mov_b32 v235, 0
v_mov_b32 v236, 0
v_mov_b32 v237, 0
v_mov_b32 v238, 0
v_mov_b32 v239, 0
v_mov_b32 v240, 0
v_mov_b32 v241, 0
v_mov_b32 v242, 0
v_mov_b32 v243, 0
v_mov_b32 v244, 0
v_mov_b32 v245, 0
v_mov_b32 v246, 0
v_mov_b32 v247, 0
v_mov_b32 v248, 0
v_mov_b32 v249, 0
v_mov_b32 v250, 0
v_mov_b32 v251, 0
v_mov_b32 v252, 0
v_mov_b32 v253, 0
v_mov_b32 v254, 0
v_mov_b32 v255, 0
s_add_u32 s28, s65, s64
s_and_b32 s28, s28, 1
s_andn2_b32 s29, s65, 1
s_or_b32 s28, s28, s29
s_lshl_b32 s30, s28, 19
s_add_u32 s30, s30, s37
s_lshl_b32 s29, s28, 7
s_add_u32 s65, s65, 1
s_add_u32 m0, s60, 20480
s_nop 0
buffer_load_dwordx4 v14, s[4:7], s29 offen offset:0 lds
buffer_load_dwordx4 v15, s[4:7], s29 offen offset:1024 lds
buffer_load_dwordx4 v16, s[4:7], s29 offen offset:2048 lds
buffer_load_dwordx4 v17, s[4:7], s29 offen offset:3072 lds
s_add_u32 m0, s60, 24576
s_nop 0
buffer_load_dwordx4 v18, s[4:7], s29 offen lds
s_add_u32 m0, s61, 32768
s_nop 0
buffer_load_dwordx4 v19, s[8:11], s30 offen offset:0 lds
buffer_load_dwordx4 v20, s[8:11], s30 offen offset:1024 lds
buffer_load_dwordx4 v21, s[8:11], s30 offen offset:2048 lds
buffer_load_dwordx4 v22, s[8:11], s30 offen offset:3072 lds
s_add_u32 s30, s30, 128
s_add_u32 m0, s61, 49152
s_nop 0
buffer_load_dwordx4 v19, s[8:11], s30 offen offset:0 lds
buffer_load_dwordx4 v20, s[8:11], s30 offen offset:1024 lds
buffer_load_dwordx4 v21, s[8:11], s30 offen offset:2048 lds
buffer_load_dwordx4 v22, s[8:11], s30 offen offset:3072 lds
s_add_u32 s28, s65, s64
s_and_b32 s28, s28, 1
s_andn2_b32 s29, s65, 1
s_or_b32 s28, s28, s29
s_lshl_b32 s30, s28, 19
s_add_u32 s30, s30, s37
s_lshl_b32 s29, s28, 7
s_add_u32 s65, s65, 1
s_waitcnt vmcnt(18)
s_barrier
ds_read_b64_tr_b16 a[192:193], v23 offset:0
ds_read_b128 a[152:155], v4 offset:0
ds_read_b64_tr_b16 a[194:195], v23 offset:1024
ds_read_b64_tr_b16 a[196:197], v23 offset:8192
ds_read_b128 a[172:175], v5 offset:0
ds_read_b64_tr_b16 a[198:199], v23 offset:9216
ds_read_b64_tr_b16 a[200:201], v24 offset:0
ds_read_b128 a[156:159], v4 offset:2048
ds_read_b64_tr_b16 a[202:203], v24 offset:1024
ds_read_b64_tr_b16 a[204:205], v24 offset:8192
ds_read_b128 a[176:179], v5 offset:2048
ds_read_b64_tr_b16 a[206:207], v24 offset:9216
ds_read_b64_tr_b16 a[208:209], v25 offset:0
ds_read_b128 a[160:163], v4 offset:4096
ds_read_b64_tr_b16 a[210:211], v25 offset:1024
ds_read_b64_tr_b16 a[212:213], v25 offset:8192
ds_read_b128 a[180:183], v5 offset:4096
ds_read_b64_tr_b16 a[214:215], v25 offset:9216
ds_read_b64_tr_b16 a[216:217], v26 offset:0
ds_read_b128 a[164:167], v4 offset:6144
ds_read_b64_tr_b16 a[218:219], v26 offset:1024
ds_read_b64_tr_b16 a[220:221], v26 offset:8192
ds_read_b128 a[184:187], v5 offset:6144
ds_read_b64_tr_b16 a[222:223], v26 offset:9216
ds_read_b128 a[168:171], v4 offset:8192
ds_read_b128 a[188:191], v5 offset:8192
s_waitcnt vmcnt(14) lgkmcnt(0)
s_barrier
s_branch L_p_loop_in
.p2align 3
L_p_loop:
v_mfma_f32_16x16x32_bf16 v[124:127], a[248:251], v[56:59], v[124:127]
s_waitcnt vmcnt(13) lgkmcnt(0)
s_barrier
L_p_loop_in:
v_mfma_f32_16x16x32_bf16 v[96:99], a[192:195], a[152:155], v[96:99]
s_add_u32 m0, s60, 0
v_mfma_f32_16x16x32_bf16 v[96:99], a[196:199], a[172:175], v[96:99]
buffer_load_dwordx4 v14, s[4:7], s29 offen offset:0 lds
ds_read_b64_tr_b16 a[224:225], v23 offset:16384
ds_read_b64_tr_b16 a[226:227], v23 offset:17408
ds_read_b64_tr_b16 a[228:229], v23 offset:24576
v_mfma_f32_16x16x32_bf16 v[128:131], a[196:199], a[176:179], v[128:131]
v_mfma_f32_16x16x32_bf16 v[128:131], a[192:195], a[156:159], v[128:131]
v_mfma_f32_16x16x32_bf16 v[160:163], a[192:195], a[160:163], v[160:163]
v_mfma_f32_16x16x32_bf16 v[160:163], a[196:199], a[180:183], v[160:163]
buffer_load_dwordx4 v15, s[4:7], s29 offen offset:1024 lds
v_mfma_f32_16x16x32_bf16 v[192:195], a[196:199], a[184:187], v[192:195]
ds_read_b64_tr_b16 a[230:231], v23 offset:25600
ds_read_b64_tr_b16 a[232:233], v24 offset:16384
ds_read_b64_tr_b16 a[234:235], v24 offset:17408
v_mfma_f32_16x16x32_bf16 v[192:195], a[192:195], a[164:167], v[192:195]
v_mfma_f32_16x16x32_bf16 v[224:227], a[192:195], a[168:171], v[224:227]
v_mfma_f32_16x16x32_bf16 v[224:227], a[196:199], a[188:191], v[224:227]
buffer_load_dwordx4 v16, s[4:7], s29 offen offset:2048 lds
v_mfma_f32_16x16x32_bf16 v[228:231], a[204:207], a[188:191], v[228:231]
v_mfma_f32_16x16x32_bf16 v[228:231], a[200:203], a[168:171], v[228:231]
ds_read_b64_tr_b16 a[236:237], v24 offset:24576
ds_read_b64_tr_b16 a[238:239], v24 offset:25600
ds_read_b64_tr_b16 a[240:241], v25 offset:16384
v_mfma_f32_16x16x32_bf16 v[196:199], a[200:203], a[164:167], v[196:199]
v_mfma_f32_16x16x32_bf16 v[196:199], a[204:207], a[184:187], v[196:199]
buffer_load_dwordx4 v17, s[4:7], s29 offen offset:3072 lds
v_mfma_f32_16x16x32_bf16 v[164:167], a[204:207], a[180:183], v[164:167]
s_add_u32 m0, s60, 4096
v_mfma_f32_16x16x32_bf16 v[164:167], a[200:203], a[160:163], v[164:167]
v_mfma_f32_16x16x32_bf16 v[132:135], a[200:203], a[156:159], v[132:135]
ds_read_b64_tr_b16 a[242:243], v25 offset:17408
ds_read_b64_tr_b16 a[244:245], v25 offset:24576
ds_read_b64_tr_b16 a[246:247], v25 offset:25600
v_mfma_f32_16x16x32_bf16 v[132:135], a[204:207], a[176:179], v[132:135]
buffer_load_dwordx4 v18, s[4:7], s29 offen lds
v_mfma_f32_16x16x32_bf16 v[100:103], a[204:207], a[172:175], v[100:103]
s_add_u32 m0, s61, 0
v_mfma_f32_16x16x32_bf16 v[100:103], a[200:203], a[152:155], v[100:103]
v_mfma_f32_16x16x32_bf16 v[104:107], a[208:211], a[152:155], v[104:107]
v_mfma_f32_16x16x32_bf16 v[104:107], a[212:215], a[172:175], v[104:107]
buffer_load_dwordx4 v19, s[8:11], s30 offen offset:0 lds
ds_read_b64_tr_b16 a[248:249], v26 offset:16384
ds_read_b64_tr_b16 a[250:251], v26 offset:17408
ds_read_b64_tr_b16 a[252:253], v26 offset:24576
v_mfma_f32_16x16x32_bf16 v[136:139], a[212:215], a[176:179], v[136:139]
v_mfma_f32_16x16x32_bf16 v[136:139], a[208:211], a[156:159], v[136:139]
v_mfma_f32_16x16x32_bf16 v[168:171], a[208:211], a[160:163], v[168:171]
v_mfma_f32_16x16x32_bf16 v[168:171], a[212:215], a[180:183], v[168:171]
buffer_load_dwordx4 v20, s[8:11], s30 offen offset:1024 lds
v_mfma_f32_16x16x32_bf16 v[200:203], a[212:215], a[184:187], v[200:203]
ds_read_b64_tr_b16 a[254:255], v26 offset:25600
v_mfma_f32_16x16x32_bf16 v[200:203], a[208:211], a[164:167], v[200:203]
v_mfma_f32_16x16x32_bf16 v[232:235], a[208:211], a[168:171], v[232:235]
v_mfma_f32_16x16x32_bf16 v[232:235], a[212:215], a[188:191], v[232:235]
buffer_load_dwordx4 v21, s[8:11], s30 offen offset:2048 lds
v_mfma_f32_16x16x32_bf16 v[236:239], a[220:223], a[188:191], v[236:239]
v_mfma_f32_16x16x32_bf16 v[236:239], a[216:219], a[168:171], v[236:239]
v_mfma_f32_16x16x32_bf16 v[204:207], a[216:219], a[164:167], v[204:207]
v_mfma_f32_16x16x32_bf16 v[204:207], a[220:223], a[184:187], v[204:207]
buffer_load_dwordx4 v22, s[8:11], s30 offen offset:3072 lds
v_mfma_f32_16x16x32_bf16 v[172:175], a[220:223], a[180:183], v[172:175]
s_add_u32 s30, s30, 128
v_mfma_f32_16x16x32_bf16 v[172:175], a[216:219], a[160:163], v[172:175]
v_mfma_f32_16x16x32_bf16 v[140:143], a[216:219], a[156:159], v[140:143]
v_mfma_f32_16x16x32_bf16 v[140:143], a[220:223], a[176:179], v[140:143]
v_mfma_f32_16x16x32_bf16 v[108:111], a[220:223], a[172:175], v[108:111]
v_mfma_f32_16x16x32_bf16 v[108:111], a[216:219], a[152:155], v[108:111]
s_waitcnt vmcnt(13) lgkmcnt(0)
s_barrier
v_mfma_f32_16x16x32_bf16 v[112:115], a[224:227], a[152:155], v[112:115]
s_add_u32 m0, s61, 16384
v_mfma_f32_16x16x32_bf16 v[112:115], a[228:231], a[172:175], v[112:115]
buffer_load_dwordx4 v19, s[8:11], s30 offen offset:0 lds
ds_read_b64_tr_b16 a[192:193], v23 offset:32768
ds_read_b128 v[56:59], v4 offset:20480
ds_read_b64_tr_b16 a[194:195], v23 offset:33792
v_mfma_f32_16x16x32_bf16 v[144:147], a[228:231], a[176:179], v[144:147]
v_mfma_f32_16x16x32_bf16 v[144:147], a[224:227], a[156:159], v[144:147]
v_mfma_f32_16x16x32_bf16 v[176:179], a[224:227], a[160:163], v[176:179]
ds_read_b64_tr_b16 a[196:197], v23 offset:40960
ds_read_b128 v[76:79], v5 offset:20480
ds_read_b64_tr_b16 a[198:199], v23 offset:41984
v_mfma_f32_16x16x32_bf16 v[176:179], a[228:231], a[180:183], v[176:179]
v_mfma_f32_16x16x32_bf16 v[208:211], a[228:231], a[184:187], v[208:211]
buffer_load_dwordx4 v20, s[8:11], s30 offen offset:1024 lds
v_mfma_f32_16x16x32_bf16 v[208:211], a[224:227], a[164:167], v[208:211]
ds_read_b64_tr_b16 a[200:201], v24 offset:32768
ds_read_b128 v[60:63], v4 offset:22528
ds_read_b64_tr_b16 a[202:203], v24 offset:33792
v_mfma_f32_16x16x32_bf16 v[240:243], a[224:227], a[168:171], v[240:243]
v_mfma_f32_16x16x32_bf16 v[240:243], a[228:231], a[188:191], v[240:243]
v_mfma_f32_16x16x32_bf16 v[244:247], a[236:239], a[188:191], v[244:247]
v_mfma_f32_16x16x32_bf16 v[244:247], a[232:235], a[168:171], v[244:247]
ds_read_b64_tr_b16 a[204:205], v24 offset:40960
ds_read_b128 v[80:83], v5 offset:22528
ds_read_b64_tr_b16 a[206:207], v24 offset:41984
v_mfma_f32_16x16x32_bf16 v[212:215], a[232:235], a[164:167], v[212:215]
buffer_load_dwordx4 v21, s[8:11], s30 offen offset:2048 lds
v_mfma_f32_16x16x32_bf16 v[212:215], a[236:239], a[184:187], v[212:215]
v_mfma_f32_16x16x32_bf16 v[180:183], a[236:239], a[180:183], v[180:183]
ds_read_b64_tr_b16 a[208:209], v25 offset:32768
ds_read_b128 v[64:67], v4 offset:24576
ds_read_b64_tr_b16 a[210:211], v25 offset:33792
v_mfma_f32_16x16x32_bf16 v[180:183], a[232:235], a[160:163], v[180:183]
v_mfma_f32_16x16x32_bf16 v[148:151], a[232:235], a[156:159], v[148:151]
v_mfma_f32_16x16x32_bf16 v[148:151], a[236:239], a[176:179], v[148:151]
buffer_load_dwordx4 v22, s[8:11], s30 offen offset:3072 lds
ds_read_b64_tr_b16 a[212:213], v25 offset:40960
ds_read_b128 v[84:87], v5 offset:24576
ds_read_b64_tr_b16 a[214:215], v25 offset:41984
v_mfma_f32_16x16x32_bf16 v[116:119], a[236:239], a[172:175], v[116:119]
v_mfma_f32_16x16x32_bf16 v[116:119], a[232:235], a[152:155], v[116:119]
v_mfma_f32_16x16x32_bf16 v[120:123], a[240:243], a[152:155], v[120:123]
v_mfma_f32_16x16x32_bf16 v[120:123], a[244:247], a[172:175], v[120:123]
ds_read_b64_tr_b16 a[216:217], v26 offset:32768
ds_read_b128 v[68:71], v4 offset:26624
ds_read_b64_tr_b16 a[218:219], v26 offset:33792
v_mfma_f32_16x16x32_bf16 v[152:155], a[244:247], a[176:179], v[152:155]
v_mfma_f32_16x16x32_bf16 v[152:155], a[240:243], a[156:159], v[152:155]
v_mfma_f32_16x16x32_bf16 v[184:187], a[240:243], a[160:163], v[184:187]
s_add_u32 s28, s65, s64
s_and_b32 s28, s28, 1
ds_read_b64_tr_b16 a[220:221], v26 offset:40960
ds_read_b128 v[88:91], v5 offset:26624
ds_read_b64_tr_b16 a[222:223], v26 offset:41984
v_mfma_f32_16x16x32_bf16 v[184:187], a[244:247], a[180:183], v[184:187]
s_andn2_b32 s29, s65, 1
s_or_b32 s28, s28, s29
v_mfma_f32_16x16x32_bf16 v[216:219], a[244:247], a[184:187], v[216:219]
s_lshl_b32 s30, s28, 19
s_add_u32 s30, s30, s37
v_mfma_f32_16x16x32_bf16 v[216:219], a[240:243], a[164:167], v[216:219]
s_lshl_b32 s29, s28, 7
s_add_u32 s65, s65, 1
ds_read_b128 v[72:75], v4 offset:28672
ds_read_b128 v[92:95], v5 offset:28672
v_mfma_f32_16x16x32_bf16 v[248:251], a[240:243], a[168:171], v[248:251]
v_mfma_f32_16x16x32_bf16 v[248:251], a[244:247], a[188:191], v[248:251]
v_mfma_f32_16x16x32_bf16 v[252:255], a[252:255], a[188:191], v[252:255]
v_mfma_f32_16x16x32_bf16 v[252:255], a[248:251], a[168:171], v[252:255]
v_mfma_f32_16x16x32_bf16 v[220:223], a[248:251], a[164:167], v[220:223]
v_mfma_f32_16x16x32_bf16 v[220:223], a[252:255], a[184:187], v[220:223]
v_mfma_f32_16x16x32_bf16 v[188:191], a[252:255], a[180:183], v[188:191]
v_mfma_f32_16x16x32_bf16 v[188:191], a[248:251], a[160:163], v[188:191]
v_mfma_f32_16x16x32_bf16 v[156:159], a[248:251], a[156:159], v[156:159]
v_mfma_f32_16x16x32_bf16 v[156:159], a[252:255], a[176:179], v[156:159]
v_mfma_f32_16x16x32_bf16 v[124:127], a[252:255], a[172:175], v[124:127]
v_mfma_f32_16x16x32_bf16 v[124:127], a[248:251], a[152:155], v[124:127]
s_waitcnt vmcnt(13) lgkmcnt(0)
s_barrier
v_mfma_f32_16x16x32_bf16 v[96:99], a[192:195], v[56:59], v[96:99]
s_add_u32 m0, s60, 20480
v_mfma_f32_16x16x32_bf16 v[96:99], a[196:199], v[76:79], v[96:99]
buffer_load_dwordx4 v14, s[4:7], s29 offen offset:0 lds
ds_read_b64_tr_b16 a[224:225], v23 offset:49152
ds_read_b64_tr_b16 a[226:227], v23 offset:50176
ds_read_b64_tr_b16 a[228:229], v23 offset:57344
v_mfma_f32_16x16x32_bf16 v[128:131], a[196:199], v[80:83], v[128:131]
v_mfma_f32_16x16x32_bf16 v[128:131], a[192:195], v[60:63], v[128:131]
v_mfma_f32_16x16x32_bf16 v[160:163], a[192:195], v[64:67], v[160:163]
v_mfma_f32_16x16x32_bf16 v[160:163], a[196:199], v[84:87], v[160:163]
buffer_load_dwordx4 v15, s[4:7], s29 offen offset:1024 lds
v_mfma_f32_16x16x32_bf16 v[192:195], a[196:199], v[88:91], v[192:195]
ds_read_b64_tr_b16 a[230:231], v23 offset:58368
ds_read_b64_tr_b16 a[232:233], v24 offset:49152
ds_read_b64_tr_b16 a[234:235], v24 offset:50176
v_mfma_f32_16x16x32_bf16 v[192:195], a[192:195], v[68:71], v[192:195]
v_mfma_f32_16x16x32_bf16 v[224:227], a[192:195], v[72:75], v[224:227]
v_mfma_f32_16x16x32_bf16 v[224:227], a[196:199], v[92:95], v[224:227]
buffer_load_dwordx4 v16, s[4:7], s29 offen offset:2048 lds
v_mfma_f32_16x16x32_bf16 v[228:231], a[204:207], v[92:95], v[228:231]
v_mfma_f32_16x16x32_bf16 v[228:231], a[200:203], v[72:75], v[228:231]
ds_read_b64_tr_b16 a[236:237], v24 offset:57344
ds_read_b64_tr_b16 a[238:239], v24 offset:58368
ds_read_b64_tr_b16 a[240:241], v25 offset:49152
v_mfma_f32_16x16x32_bf16 v[196:199], a[200:203], v[68:71], v[196:199]
v_mfma_f32_16x16x32_bf16 v[196:199], a[204:207], v[88:91], v[196:199]
buffer_load_dwordx4 v17, s[4:7], s29 offen offset:3072 lds
v_mfma_f32_16x16x32_bf16 v[164:167], a[204:207], v[84:87], v[164:167]
s_add_u32 m0, s60, 24576
v_mfma_f32_16x16x32_bf16 v[164:167], a[200:203], v[64:67], v[164:167]
v_mfma_f32_16x16x32_bf16 v[132:135], a[200:203], v[60:63], v[132:135]
ds_read_b64_tr_b16 a[242:243], v25 offset:50176
ds_read_b64_tr_b16 a[244:245], v25 offset:57344
ds_read_b64_tr_b16 a[246:247], v25 offset:58368
v_mfma_f32_16x16x32_bf16 v[132:135], a[204:207], v[80:83], v[132:135]
buffer_load_dwordx4 v18, s[4:7], s29 offen lds
v_mfma_f32_16x16x32_bf16 v[100:103], a[204:207], v[76:79], v[100:103]
s_add_u32 m0, s61, 32768
v_mfma_f32_16x16x32_bf16 v[100:103], a[200:203], v[56:59], v[100:103]
v_mfma_f32_16x16x32_bf16 v[104:107], a[208:211], v[56:59], v[104:107]
v_mfma_f32_16x16x32_bf16 v[104:107], a[212:215], v[76:79], v[104:107]
buffer_load_dwordx4 v19, s[8:11], s30 offen offset:0 lds
ds_read_b64_tr_b16 a[248:249], v26 offset:49152
ds_read_b64_tr_b16 a[250:251], v26 offset:50176
ds_read_b64_tr_b16 a[252:253], v26 offset:57344
v_mfma_f32_16x16x32_bf16 v[136:139], a[212:215], v[80:83], v[136:139]
v_mfma_f32_16x16x32_bf16 v[136:139], a[208:211], v[60:63], v[136:139]
v_mfma_f32_16x16x32_bf16 v[168:171], a[208:211], v[64:67], v[168:171]
v_mfma_f32_16x16x32_bf16 v[168:171], a[212:215], v[84:87], v[168:171]
buffer_load_dwordx4 v20, s[8:11], s30 offen offset:1024 lds
v_mfma_f32_16x16x32_bf16 v[200:203], a[212:215], v[88:91], v[200:203]
ds_read_b64_tr_b16 a[254:255], v26 offset:58368
v_mfma_f32_16x16x32_bf16 v[200:203], a[208:211], v[68:71], v[200:203]
v_mfma_f32_16x16x32_bf16 v[232:235], a[208:211], v[72:75], v[232:235]
v_mfma_f32_16x16x32_bf16 v[232:235], a[212:215], v[92:95], v[232:235]
buffer_load_dwordx4 v21, s[8:11], s30 offen offset:2048 lds
v_mfma_f32_16x16x32_bf16 v[236:239], a[220:223], v[92:95], v[236:239]
v_mfma_f32_16x16x32_bf16 v[236:239], a[216:219], v[72:75], v[236:239]
v_mfma_f32_16x16x32_bf16 v[204:207], a[216:219], v[68:71], v[204:207]
v_mfma_f32_16x16x32_bf16 v[204:207], a[220:223], v[88:91], v[204:207]
buffer_load_dwordx4 v22, s[8:11], s30 offen offset:3072 lds
v_mfma_f32_16x16x32_bf16 v[172:175], a[220:223], v[84:87], v[172:175]
s_add_u32 s30, s30, 128
v_mfma_f32_16x16x32_bf16 v[172:175], a[216:219], v[64:67], v[172:175]
v_mfma_f32_16x16x32_bf16 v[140:143], a[216:219], v[60:63], v[140:143]
v_mfma_f32_16x16x32_bf16 v[140:143], a[220:223], v[80:83], v[140:143]
v_mfma_f32_16x16x32_bf16 v[108:111], a[220:223], v[76:79], v[108:111]
v_mfma_f32_16x16x32_bf16 v[108:111], a[216:219], v[56:59], v[108:111]
s_waitcnt vmcnt(13) lgkmcnt(0)
s_barrier
v_mfma_f32_16x16x32_bf16 v[112:115], a[224:227], v[56:59], v[112:115]
s_add_u32 m0, s61, 49152
v_mfma_f32_16x16x32_bf16 v[112:115], a[228:231], v[76:79], v[112:115]
buffer_load_dwordx4 v19, s[8:11], s30 offen offset:0 lds
ds_read_b64_tr_b16 a[192:193], v23 offset:0
ds_read_b128 a[152:155], v4 offset:0
ds_read_b64_tr_b16 a[194:195], v23 offset:1024
v_mfma_f32_16x16x32_bf16 v[144:147], a[228:231], v[80:83], v[144:147]
v_mfma_f32_16x16x32_bf16 v[144:147], a[224:227], v[60:63], v[144:147]
v_mfma_f32_16x16x32_bf16 v[176:179], a[224:227], v[64:67], v[176:179]
ds_read_b64_tr_b16 a[196:197], v23 offset:8192
ds_read_b128 a[172:175], v5 offset:0
ds_read_b64_tr_b16 a[198:199], v23 offset:9216
v_mfma_f32_16x16x32_bf16 v[176:179], a[228:231], v[84:87], v[176:179]
v_mfma_f32_16x16x32_bf16 v[208:211], a[228:231], v[88:91], v[208:211]
buffer_load_dwordx4 v20, s[8:11], s30 offen offset:1024 lds
v_mfma_f32_16x16x32_bf16 v[208:211], a[224:227], v[68:71], v[208:211]
ds_read_b64_tr_b16 a[200:201], v24 offset:0
ds_read_b128 a[156:159], v4 offset:2048
ds_read_b64_tr_b16 a[202:203], v24 offset:1024
v_mfma_f32_16x16x32_bf16 v[240:243], a[224:227], v[72:75], v[240:243]
v_mfma_f32_16x16x32_bf16 v[240:243], a[228:231], v[92:95], v[240:243]
v_mfma_f32_16x16x32_bf16 v[244:247], a[236:239], v[92:95], v[244:247]
v_mfma_f32_16x16x32_bf16 v[244:247], a[232:235], v[72:75], v[244:247]
ds_read_b64_tr_b16 a[204:205], v24 offset:8192
ds_read_b128 a[176:179], v5 offset:2048
ds_read_b64_tr_b16 a[206:207], v24 offset:9216
v_mfma_f32_16x16x32_bf16 v[212:215], a[232:235], v[68:71], v[212:215]
buffer_load_dwordx4 v21, s[8:11], s30 offen offset:2048 lds
v_mfma_f32_16x16x32_bf16 v[212:215], a[236:239], v[88:91], v[212:215]
v_mfma_f32_16x16x32_bf16 v[180:183], a[236:239], v[84:87], v[180:183]
ds_read_b64_tr_b16 a[208:209], v25 offset:0
ds_read_b128 a[160:163], v4 offset:4096
ds_read_b64_tr_b16 a[210:211], v25 offset:1024
v_mfma_f32_16x16x32_bf16 v[180:183], a[232:235], v[64:67], v[180:183]
v_mfma_f32_16x16x32_bf16 v[148:151], a[232:235], v[60:63], v[148:151]
v_mfma_f32_16x16x32_bf16 v[148:151], a[236:239], v[80:83], v[148:151]
buffer_load_dwordx4 v22, s[8:11], s30 offen offset:3072 lds
ds_read_b64_tr_b16 a[212:213], v25 offset:8192
ds_read_b128 a[180:183], v5 offset:4096
ds_read_b64_tr_b16 a[214:215], v25 offset:9216
v_mfma_f32_16x16x32_bf16 v[116:119], a[236:239], v[76:79], v[116:119]
v_mfma_f32_16x16x32_bf16 v[116:119], a[232:235], v[56:59], v[116:119]
v_mfma_f32_16x16x32_bf16 v[120:123], a[240:243], v[56:59], v[120:123]
v_mfma_f32_16x16x32_bf16 v[120:123], a[244:247], v[76:79], v[120:123]
ds_read_b64_tr_b16 a[216:217], v26 offset:0
ds_read_b128 a[164:167], v4 offset:6144
ds_read_b64_tr_b16 a[218:219], v26 offset:1024
v_mfma_f32_16x16x32_bf16 v[152:155], a[244:247], v[80:83], v[152:155]
v_mfma_f32_16x16x32_bf16 v[152:155], a[240:243], v[60:63], v[152:155]
v_mfma_f32_16x16x32_bf16 v[184:187], a[240:243], v[64:67], v[184:187]
s_add_u32 s28, s65, s64
s_and_b32 s28, s28, 1
ds_read_b64_tr_b16 a[220:221], v26 offset:8192
ds_read_b128 a[184:187], v5 offset:6144
ds_read_b64_tr_b16 a[222:223], v26 offset:9216
v_mfma_f32_16x16x32_bf16 v[184:187], a[244:247], v[84:87], v[184:187]
s_andn2_b32 s29, s65, 1
s_or_b32 s28, s28, s29
v_mfma_f32_16x16x32_bf16 v[216:219], a[244:247], v[88:91], v[216:219]
s_lshl_b32 s30, s28, 19
s_add_u32 s30, s30, s37
v_mfma_f32_16x16x32_bf16 v[216:219], a[240:243], v[68:71], v[216:219]
s_lshl_b32 s29, s28, 7
s_add_u32 s65, s65, 1
ds_read_b128 a[168:171], v4 offset:8192
ds_read_b128 a[188:191], v5 offset:8192
v_mfma_f32_16x16x32_bf16 v[248:251], a[240:243], v[72:75], v[248:251]
v_mfma_f32_16x16x32_bf16 v[248:251], a[244:247], v[92:95], v[248:251]
v_mfma_f32_16x16x32_bf16 v[252:255], a[252:255], v[92:95], v[252:255]
v_mfma_f32_16x16x32_bf16 v[252:255], a[248:251], v[72:75], v[252:255]
v_mfma_f32_16x16x32_bf16 v[220:223], a[248:251], v[68:71], v[220:223]
v_mfma_f32_16x16x32_bf16 v[220:223], a[252:255], v[88:91], v[220:223]
v_mfma_f32_16x16x32_bf16 v[188:191], a[252:255], v[84:87], v[188:191]
v_mfma_f32_16x16x32_bf16 v[188:191], a[248:251], v[64:67], v[188:191]
v_mfma_f32_16x16x32_bf16 v[156:159], a[248:251], v[60:63], v[156:159]
v_mfma_f32_16x16x32_bf16 v[156:159], a[252:255], v[80:83], v[156:159]
s_cmp_lt_u32 s65, s38
v_mfma_f32_16x16x32_bf16 v[124:127], a[252:255], v[76:79], v[124:127]
s_cbranch_scc1 L_p_loop
s_cmp_ge_u32 s65, 17
s_cbranch_scc1 L_p_done
s_cmp_ge_u32 s65, 15
s_cbranch_scc1 L_p_pf
v_mov_b32 v12, 1
s_and_b32 s28, s2, 63
s_lshl_b32 s28, s28, 2
s_mov_b64 exec, 1
buffer_atomic_add v12, off, s[68:71], s28 sc1
s_mov_b64 exec, -1
s_mov_b32 s38, 15
s_branch L_p_loop
L_p_pf:
s_getpc_b64 s[48:49]
L_pcb:
s_mov_b32 s50, L_code_end-L_pcb
s_mov_b32 s51, 0x20000
v_lshrrev_b32 v6, 5, v0
s_lshr_b32 s28, s2, 3
s_lshl_b32 s28, s28, 10
v_lshlrev_b32 v6, 7, v6
buffer_load_dword v7, v6, s[48:51], s28 offen
s_branch L_p_loop
L_p_done:
v_mfma_f32_16x16x32_bf16 v[124:127], a[248:251], v[56:59], v[124:127]
s_waitcnt vmcnt(13) lgkmcnt(0)
s_barrier
v_lshlrev_b32 v12, 2, v2
s_mov_b32 s46, s3
v_mfma_f32_16x16x32_bf16 v[96:99], a[192:195], a[152:155], v[96:99]
v_accvgpr_write_b32 a0, 0
v_accvgpr_write_b32 a1, 0
v_mfma_f32_16x16x32_bf16 v[96:99], a[196:199], a[172:175], v[96:99]
buffer_load_dword v13, v12, s[68:71], 0 offen sc1
v_mfma_f32_16x16x32_bf16 v[128:131], a[196:199], a[176:179], v[128:131]
s_add_u32 m0, s62, 0
ds_read_b64_tr_b16 a[224:225], v23 offset:16384
v_mfma_f32_16x16x32_bf16 v[128:131], a[192:195], a[156:159], v[128:131]
ds_read_b64_tr_b16 a[226:227], v23 offset:17408
v_accvgpr_write_b32 a2, 0
v_mfma_f32_16x16x32_bf16 v[160:163], a[192:195], a[160:163], v[160:163]
ds_read_b64_tr_b16 a[228:229], v23 offset:24576
v_accvgpr_write_b32 a3, 0
v_mfma_f32_16x16x32_bf16 v[160:163], a[196:199], a[180:183], v[160:163]
buffer_load_dwordx4 v47, s[12:15], s46 offen offset:0 nt lds
v_mfma_f32_16x16x32_bf16 v[192:195], a[196:199], a[184:187], v[192:195]
ds_read_b64_tr_b16 a[230:231], v23 offset:25600
v_accvgpr_write_b32 a4, 0
v_mfma_f32_16x16x32_bf16 v[192:195], a[192:195], a[164:167], v[192:195]
v_accvgpr_write_b32 a5, 0
v_accvgpr_write_b32 a6, 0
v_mfma_f32_16x16x32_bf16 v[224:227], a[192:195], a[168:171], v[224:227]
ds_read_b64_tr_b16 a[232:233], v24 offset:16384
v_accvgpr_write_b32 a7, 0
v_mfma_f32_16x16x32_bf16 v[224:227], a[196:199], a[188:191], v[224:227]
buffer_load_dwordx4 v48, s[12:15], s46 offen offset:1024 nt lds
v_mfma_f32_16x16x32_bf16 v[228:231], a[204:207], a[188:191], v[228:231]
ds_read_b64_tr_b16 a[234:235], v24 offset:17408
v_accvgpr_write_b32 a8, 0
v_mfma_f32_16x16x32_bf16 v[228:231], a[200:203], a[168:171], v[228:231]
v_accvgpr_write_b32 a9, 0
v_accvgpr_write_b32 a10, 0
v_mfma_f32_16x16x32_bf16 v[196:199], a[200:203], a[164:167], v[196:199]
ds_read_b64_tr_b16 a[236:237], v24 offset:24576
v_accvgpr_write_b32 a11, 0
v_mfma_f32_16x16x32_bf16 v[196:199], a[204:207], a[184:187], v[196:199]
buffer_load_dwordx4 v49, s[12:15], s46 offen offset:2048 nt lds
v_mfma_f32_16x16x32_bf16 v[164:167], a[204:207], a[180:183], v[164:167]
ds_read_b64_tr_b16 a[238:239], v24 offset:25600
v_accvgpr_write_b32 a12, 0
v_mfma_f32_16x16x32_bf16 v[164:167], a[200:203], a[160:163], v[164:167]
v_accvgpr_write_b32 a13, 0
v_accvgpr_write_b32 a14, 0
v_mfma_f32_16x16x32_bf16 v[132:135], a[200:203], a[156:159], v[132:135]
ds_read_b64_tr_b16 a[240:241], v25 offset:16384
v_accvgpr_write_b32 a15, 0
v_mfma_f32_16x16x32_bf16 v[132:135], a[204:207], a[176:179], v[132:135]
buffer_load_dwordx4 v50, s[12:15], s46 offen offset:3072 nt lds
v_mfma_f32_16x16x32_bf16 v[100:103], a[204:207], a[172:175], v[100:103]
s_add_u32 m0, s62, 4096
s_add_u32 s46, s46, 65536
v_mfma_f32_16x16x32_bf16 v[100:103], a[200:203], a[152:155], v[100:103]
ds_read_b64_tr_b16 a[242:243], v25 offset:17408
ds_read_b64_tr_b16 a[244:245], v25 offset:24576
v_mfma_f32_16x16x32_bf16 v[104:107], a[208:211], a[152:155], v[104:107]
v_accvgpr_write_b32 a16, 0
v_accvgpr_write_b32 a17, 0
v_mfma_f32_16x16x32_bf16 v[104:107], a[212:215], a[172:175], v[104:107]
buffer_load_dwordx4 v47, s[12:15], s46 offen offset:0 nt lds
v_mfma_f32_16x16x32_bf16 v[136:139], a[212:215], a[176:179], v[136:139]
ds_read_b64_tr_b16 a[246:247], v25 offset:25600
v_accvgpr_write_b32 a18, 0
v_mfma_f32_16x16x32_bf16 v[136:139], a[208:211], a[156:159], v[136:139]
ds_read_b64_tr_b16 a[248:249], v26 offset:16384
v_accvgpr_write_b32 a19, 0
v_mfma_f32_16x16x32_bf16 v[168:171], a[208:211], a[160:163], v[168:171]
v_accvgpr_write_b32 a20, 0
v_accvgpr_write_b32 a21, 0
v_mfma_f32_16x16x32_bf16 v[168:171], a[212:215], a[180:183], v[168:171]
buffer_load_dwordx4 v48, s[12:15], s46 offen offset:1024 nt lds
v_mfma_f32_16x16x32_bf16 v[200:203], a[212:215], a[184:187], v[200:203]
ds_read_b64_tr_b16 a[250:251], v26 offset:17408
v_accvgpr_write_b32 a22, 0
v_mfma_f32_16x16x32_bf16 v[200:203], a[208:211], a[164:167], v[200:203]
ds_read_b64_tr_b16 a[252:253], v26 offset:24576
v_accvgpr_write_b32 a23, 0
v_mfma_f32_16x16x32_bf16 v[232:235], a[208:211], a[168:171], v[232:235]
v_accvgpr_write_b32 a24, 0
v_accvgpr_write_b32 a25, 0
v_mfma_f32_16x16x32_bf16 v[232:235], a[212:215], a[188:191], v[232:235]
buffer_load_dwordx4 v49, s[12:15], s46 offen offset:2048 nt lds
v_mfma_f32_16x16x32_bf16 v[236:239], a[220:223], a[188:191], v[236:239]
ds_read_b64_tr_b16 a[254:255], v26 offset:25600
v_accvgpr_write_b32 a26, 0
v_mfma_f32_16x16x32_bf16 v[236:239], a[216:219], a[168:171], v[236:239]
v_accvgpr_write_b32 a27, 0
v_accvgpr_write_b32 a28, 0
v_mfma_f32_16x16x32_bf16 v[204:207], a[216:219], a[164:167], v[204:207]
v_accvgpr_write_b32 a29, 0
v_accvgpr_write_b32 a30, 0
v_mfma_f32_16x16x32_bf16 v[204:207], a[220:223], a[184:187], v[204:207]
buffer_load_dwordx4 v50, s[12:15], s46 offen offset:3072 nt lds
v_mfma_f32_16x16x32_bf16 v[172:175], a[220:223], a[180:183], v[172:175]
s_add_u32 m0, s62, 32768
s_or_b32 s46, s46, 0xfffdf0ff
v_mfma_f32_16x16x32_bf16 v[172:175], a[216:219], a[160:163], v[172:175]
s_add_u32 s46, s46, 1
s_and_b32 s46, s46, 0x20f00
v_mfma_f32_16x16x32_bf16 v[140:143], a[216:219], a[156:159], v[140:143]
v_accvgpr_write_b32 a31, 0
v_accvgpr_write_b32 a32, 0
v_mfma_f32_16x16x32_bf16 v[140:143], a[220:223], a[176:179], v[140:143]
v_accvgpr_write_b32 a33, 0
v_accvgpr_write_b32 a34, 0
v_mfma_f32_16x16x32_bf16 v[108:111], a[220:223], a[172:175], v[108:111]
v_accvgpr_write_b32 a35, 0
v_accvgpr_write_b32 a36, 0
v_mfma_f32_16x16x32_bf16 v[108:111], a[216:219], a[152:155], v[108:111]
v_accvgpr_write_b32 a37, 0
v_accvgpr_write_b32 a38, 0
s_waitcnt vmcnt(13) lgkmcnt(0)
s_barrier
v_mfma_f32_16x16x32_bf16 v[112:115], a[224:227], a[152:155], v[112:115]
v_accvgpr_write_b32 a39, 0
v_accvgpr_write_b32 a40, 0
v_mfma_f32_16x16x32_bf16 v[112:115], a[228:231], a[172:175], v[112:115]
ds_read_b64_tr_b16 a[192:193], v23 offset:32768
v_accvgpr_write_b32 a41, 0
v_mfma_f32_16x16x32_bf16 v[144:147], a[228:231], a[176:179], v[144:147]
ds_read_b128 v[56:59], v4 offset:20480
v_accvgpr_write_b32 a42, 0
v_mfma_f32_16x16x32_bf16 v[144:147], a[224:227], a[156:159], v[144:147]
ds_read_b64_tr_b16 a[194:195], v23 offset:33792
v_accvgpr_write_b32 a43, 0
v_mfma_f32_16x16x32_bf16 v[176:179], a[224:227], a[160:163], v[176:179]
ds_read_b64_tr_b16 a[196:197], v23 offset:40960
v_accvgpr_write_b32 a44, 0
v_mfma_f32_16x16x32_bf16 v[176:179], a[228:231], a[180:183], v[176:179]
ds_read_b128 v[76:79], v5 offset:20480
v_accvgpr_write_b32 a45, 0
v_mfma_f32_16x16x32_bf16 v[208:211], a[228:231], a[184:187], v[208:211]
ds_read_b64_tr_b16 a[198:199], v23 offset:41984
v_accvgpr_write_b32 a46, 0
v_mfma_f32_16x16x32_bf16 v[208:211], a[224:227], a[164:167], v[208:211]
ds_read_b64_tr_b16 a[200:201], v24 offset:32768
v_accvgpr_write_b32 a47, 0
v_mfma_f32_16x16x32_bf16 v[240:243], a[224:227], a[168:171], v[240:243]
v_accvgpr_write_b32 a48, 0
v_accvgpr_write_b32 a49, 0
v_mfma_f32_16x16x32_bf16 v[240:243], a[228:231], a[188:191], v[240:243]
ds_read_b128 v[60:63], v4 offset:22528
v_accvgpr_write_b32 a50, 0
v_mfma_f32_16x16x32_bf16 v[244:247], a[236:239], a[188:191], v[244:247]
ds_read_b64_tr_b16 a[202:203], v24 offset:33792
v_accvgpr_write_b32 a51, 0
v_mfma_f32_16x16x32_bf16 v[244:247], a[232:235], a[168:171], v[244:247]
ds_read_b64_tr_b16 a[204:205], v24 offset:40960
v_accvgpr_write_b32 a52, 0
v_mfma_f32_16x16x32_bf16 v[212:215], a[232:235], a[164:167], v[212:215]
ds_read_b128 v[80:83], v5 offset:22528
v_accvgpr_write_b32 a53, 0
v_mfma_f32_16x16x32_bf16 v[212:215], a[236:239], a[184:187], v[212:215]
ds_read_b64_tr_b16 a[206:207], v24 offset:41984
v_accvgpr_write_b32 a54, 0
v_mfma_f32_16x16x32_bf16 v[180:183], a[236:239], a[180:183], v[180:183]
ds_read_b64_tr_b16 a[208:209], v25 offset:32768
v_accvgpr_write_b32 a55, 0
v_mfma_f32_16x16x32_bf16 v[180:183], a[232:235], a[160:163], v[180:183]
v_accvgpr_write_b32 a56, 0
v_accvgpr_write_b32 a57, 0
v_mfma_f32_16x16x32_bf16 v[148:151], a[232:235], a[156:159], v[148:151]
ds_read_b128 v[64:67], v4 offset:24576
v_accvgpr_write_b32 a58, 0
v_mfma_f32_16x16x32_bf16 v[148:151], a[236:239], a[176:179], v[148:151]
ds_read_b64_tr_b16 a[210:211], v25 offset:33792
v_accvgpr_write_b32 a59, 0
v_mfma_f32_16x16x32_bf16 v[116:119], a[236:239], a[172:175], v[116:119]
ds_read_b64_tr_b16 a[212:213], v25 offset:40960
v_accvgpr_write_b32 a60, 0
v_mfma_f32_16x16x32_bf16 v[116:119], a[232:235], a[152:155], v[116:119]
ds_read_b128 v[84:87], v5 offset:24576
v_accvgpr_write_b32 a61, 0
v_mfma_f32_16x16x32_bf16 v[120:123], a[240:243], a[152:155], v[120:123]
ds_read_b64_tr_b16 a[214:215], v25 offset:41984
v_accvgpr_write_b32 a62, 0
v_mfma_f32_16x16x32_bf16 v[120:123], a[244:247], a[172:175], v[120:123]
ds_read_b64_tr_b16 a[216:217], v26 offset:32768
v_accvgpr_write_b32 a63, 0
v_mfma_f32_16x16x32_bf16 v[152:155], a[244:247], a[176:179], v[152:155]
ds_read_b128 v[68:71], v4 offset:26624
v_accvgpr_write_b32 a64, 0
v_mfma_f32_16x16x32_bf16 v[152:155], a[240:243], a[156:159], v[152:155]
v_accvgpr_write_b32 a65, 0
v_accvgpr_write_b32 a66, 0
v_mfma_f32_16x16x32_bf16 v[184:187], a[240:243], a[160:163], v[184:187]
ds_read_b64_tr_b16 a[218:219], v26 offset:33792
v_accvgpr_write_b32 a67, 0
v_mfma_f32_16x16x32_bf16 v[184:187], a[244:247], a[180:183], v[184:187]
ds_read_b64_tr_b16 a[220:221], v26 offset:40960
v_accvgpr_write_b32 a68, 0
v_mfma_f32_16x16x32_bf16 v[216:219], a[244:247], a[184:187], v[216:219]
ds_read_b128 v[88:91], v5 offset:26624
v_accvgpr_write_b32 a69, 0
v_mfma_f32_16x16x32_bf16 v[216:219], a[240:243], a[164:167], v[216:219]
ds_read_b64_tr_b16 a[222:223], v26 offset:41984
v_accvgpr_write_b32 a70, 0
v_mfma_f32_16x16x32_bf16 v[248:251], a[240:243], a[168:171], v[248:251]
ds_read_b128 v[72:75], v4 offset:28672
v_accvgpr_write_b32 a71, 0
v_mfma_f32_16x16x32_bf16 v[248:251], a[244:247], a[188:191], v[248:251]
ds_read_b128 v[92:95], v5 offset:28672
v_accvgpr_write_b32 a72, 0
v_mfma_f32_16x16x32_bf16 v[252:255], a[252:255], a[188:191], v[252:255]
v_accvgpr_write_b32 a73, 0
v_accvgpr_write_b32 a74, 0
v_mfma_f32_16x16x32_bf16 v[252:255], a[248:251], a[168:171], v[252:255]
v_accvgpr_write_b32 a75, 0
v_accvgpr_write_b32 a76, 0
v_mfma_f32_16x16x32_bf16 v[220:223], a[248:251], a[164:167], v[220:223]
v_accvgpr_write_b32 a77, 0
v_accvgpr_write_b32 a78, 0
v_mfma_f32_16x16x32_bf16 v[220:223], a[252:255], a[184:187], v[220:223]
v_accvgpr_write_b32 a79, 0
v_accvgpr_write_b32 a80, 0
v_mfma_f32_16x16x32_bf16 v[188:191], a[252:255], a[180:183], v[188:191]
v_accvgpr_write_b32 a81, 0
v_accvgpr_write_b32 a82, 0
v_mfma_f32_16x16x32_bf16 v[188:191], a[248:251], a[160:163], v[188:191]
v_accvgpr_write_b32 a83, 0
v_accvgpr_write_b32 a84, 0
v_mfma_f32_16x16x32_bf16 v[156:159], a[248:251], a[156:159], v[156:159]
v_accvgpr_write_b32 a85, 0
v_accvgpr_write_b32 a86, 0
v_mfma_f32_16x16x32_bf16 v[156:159], a[252:255], a[176:179], v[156:159]
v_accvgpr_write_b32 a87, 0
v_accvgpr_write_b32 a88, 0
v_mfma_f32_16x16x32_bf16 v[124:127], a[252:255], a[172:175], v[124:127]
v_accvgpr_write_b32 a89, 0
v_accvgpr_write_b32 a90, 0
v_mfma_f32_16x16x32_bf16 v[124:127], a[248:251], a[152:155], v[124:127]
v_accvgpr_write_b32 a91, 0
v_accvgpr_write_b32 a92, 0
s_waitcnt vmcnt(9) lgkmcnt(0)
s_barrier
v_mfma_f32_16x16x32_bf16 v[96:99], a[192:195], v[56:59], v[96:99]
s_add_u32 m0, s62, 32768
v_accvgpr_write_b32 a93, 0
v_mfma_f32_16x16x32_bf16 v[96:99], a[196:199], v[76:79], v[96:99]
buffer_load_dwordx4 v47, s[12:15], s46 offen offset:0 nt lds
v_mfma_f32_16x16x32_bf16 v[128:131], a[196:199], v[80:83], v[128:131]
ds_read_b64_tr_b16 a[224:225], v23 offset:49152
ds_read_b64_tr_b16 a[226:227], v23 offset:50176
v_mfma_f32_16x16x32_bf16 v[128:131], a[192:195], v[60:63], v[128:131]
v_accvgpr_write_b32 a94, 0
v_accvgpr_write_b32 a95, 0
v_mfma_f32_16x16x32_bf16 v[160:163], a[192:195], v[64:67], v[160:163]
ds_read_b64_tr_b16 a[228:229], v23 offset:57344
v_accvgpr_write_b32 a96, 0
v_mfma_f32_16x16x32_bf16 v[160:163], a[196:199], v[84:87], v[160:163]
buffer_load_dwordx4 v48, s[12:15], s46 offen offset:1024 nt lds
v_mfma_f32_16x16x32_bf16 v[192:195], a[196:199], v[88:91], v[192:195]
ds_read_b64_tr_b16 a[230:231], v23 offset:58368
v_accvgpr_write_b32 a97, 0
v_mfma_f32_16x16x32_bf16 v[192:195], a[192:195], v[68:71], v[192:195]
v_accvgpr_write_b32 a98, 0
v_accvgpr_write_b32 a99, 0
v_mfma_f32_16x16x32_bf16 v[224:227], a[192:195], v[72:75], v[224:227]
ds_read_b64_tr_b16 a[232:233], v24 offset:49152
v_accvgpr_write_b32 a100, 0
v_mfma_f32_16x16x32_bf16 v[224:227], a[196:199], v[92:95], v[224:227]
v_accvgpr_write_b32 a101, 0
v_accvgpr_write_b32 a102, 0
v_mfma_f32_16x16x32_bf16 v[228:231], a[204:207], v[92:95], v[228:231]
buffer_load_dwordx4 v49, s[12:15], s46 offen offset:2048 nt lds
v_mfma_f32_16x16x32_bf16 v[228:231], a[200:203], v[72:75], v[228:231]
ds_read_b64_tr_b16 a[234:235], v24 offset:50176
v_accvgpr_write_b32 a103, 0
v_mfma_f32_16x16x32_bf16 v[196:199], a[200:203], v[68:71], v[196:199]
ds_read_b64_tr_b16 a[236:237], v24 offset:57344
v_accvgpr_write_b32 a104, 0
v_mfma_f32_16x16x32_bf16 v[196:199], a[204:207], v[88:91], v[196:199]
v_accvgpr_write_b32 a105, 0
v_accvgpr_write_b32 a106, 0
v_mfma_f32_16x16x32_bf16 v[164:167], a[204:207], v[84:87], v[164:167]
buffer_load_dwordx4 v50, s[12:15], s46 offen offset:3072 nt lds
v_mfma_f32_16x16x32_bf16 v[164:167], a[200:203], v[64:67], v[164:167]
s_add_u32 m0, s62, 36864
s_add_u32 s46, s46, 65536
v_mfma_f32_16x16x32_bf16 v[132:135], a[200:203], v[60:63], v[132:135]
ds_read_b64_tr_b16 a[238:239], v24 offset:58368
ds_read_b64_tr_b16 a[240:241], v25 offset:49152
v_mfma_f32_16x16x32_bf16 v[132:135], a[204:207], v[80:83], v[132:135]
ds_read_b64_tr_b16 a[242:243], v25 offset:50176
v_accvgpr_write_b32 a107, 0
v_mfma_f32_16x16x32_bf16 v[100:103], a[204:207], v[76:79], v[100:103]
v_accvgpr_write_b32 a108, 0
v_accvgpr_write_b32 a109, 0
v_mfma_f32_16x16x32_bf16 v[100:103], a[200:203], v[56:59], v[100:103]
buffer_load_dwordx4 v47, s[12:15], s46 offen offset:0 nt lds
v_mfma_f32_16x16x32_bf16 v[104:107], a[208:211], v[56:59], v[104:107]
ds_read_b64_tr_b16 a[244:245], v25 offset:57344
v_accvgpr_write_b32 a110, 0
v_mfma_f32_16x16x32_bf16 v[104:107], a[212:215], v[76:79], v[104:107]
ds_read_b64_tr_b16 a[246:247], v25 offset:58368
v_accvgpr_write_b32 a111, 0
v_mfma_f32_16x16x32_bf16 v[136:139], a[212:215], v[80:83], v[136:139]
v_accvgpr_write_b32 a112, 0
v_accvgpr_write_b32 a113, 0
v_mfma_f32_16x16x32_bf16 v[136:139], a[208:211], v[60:63], v[136:139]
buffer_load_dwordx4 v48, s[12:15], s46 offen offset:1024 nt lds
v_mfma_f32_16x16x32_bf16 v[168:171], a[208:211], v[64:67], v[168:171]
ds_read_b64_tr_b16 a[248:249], v26 offset:49152
v_accvgpr_write_b32 a114, 0
v_mfma_f32_16x16x32_bf16 v[168:171], a[212:215], v[84:87], v[168:171]
ds_read_b64_tr_b16 a[250:251], v26 offset:50176
v_accvgpr_write_b32 a115, 0
v_mfma_f32_16x16x32_bf16 v[200:203], a[212:215], v[88:91], v[200:203]
v_accvgpr_write_b32 a116, 0
v_accvgpr_write_b32 a117, 0
v_mfma_f32_16x16x32_bf16 v[200:203], a[208:211], v[68:71], v[200:203]
ds_read_b64_tr_b16 a[252:253], v26 offset:57344
v_accvgpr_write_b32 a118, 0
v_mfma_f32_16x16x32_bf16 v[232:235], a[208:211], v[72:75], v[232:235]
buffer_load_dwordx4 v49, s[12:15], s46 offen offset:2048 nt lds
v_mfma_f32_16x16x32_bf16 v[232:235], a[212:215], v[92:95], v[232:235]
ds_read_b64_tr_b16 a[254:255], v26 offset:58368
v_accvgpr_write_b32 a119, 0
v_mfma_f32_16x16x32_bf16 v[236:239], a[220:223], v[92:95], v[236:239]
v_accvgpr_write_b32 a120, 0
v_accvgpr_write_b32 a121, 0
v_mfma_f32_16x16x32_bf16 v[236:239], a[216:219], v[72:75], v[236:239]
v_accvgpr_write_b32 a122, 0
v_accvgpr_write_b32 a123, 0
v_mfma_f32_16x16x32_bf16 v[204:207], a[216:219], v[68:71], v[204:207]
buffer_load_dwordx4 v50, s[12:15], s46 offen offset:3072 nt lds
v_mfma_f32_16x16x32_bf16 v[204:207], a[220:223], v[88:91], v[204:207]
s_add_u32 m0, s62, 65536
s_or_b32 s46, s46, 0xfffdf0ff
v_mfma_f32_16x16x32_bf16 v[172:175], a[220:223], v[84:87], v[172:175]
s_add_u32 s46, s46, 1
s_and_b32 s46, s46, 0x20f00
v_mfma_f32_16x16x32_bf16 v[172:175], a[216:219], v[64:67], v[172:175]
v_accvgpr_write_b32 a124, 0
v_accvgpr_write_b32 a125, 0
v_mfma_f32_16x16x32_bf16 v[140:143], a[216:219], v[60:63], v[140:143]
v_accvgpr_write_b32 a126, 0
v_accvgpr_write_b32 a127, 0
v_mfma_f32_16x16x32_bf16 v[140:143], a[220:223], v[80:83], v[140:143]
v_accvgpr_write_b32 a128, 0
v_accvgpr_write_b32 a129, 0
v_mfma_f32_16x16x32_bf16 v[108:111], a[220:223], v[76:79], v[108:111]
v_accvgpr_write_b32 a130, 0
v_accvgpr_write_b32 a131, 0
v_mfma_f32_16x16x32_bf16 v[108:111], a[216:219], v[56:59], v[108:111]
v_accvgpr_write_b32 a132, 0
v_accvgpr_write_b32 a133, 0
s_waitcnt lgkmcnt(0)
s_barrier
v_mfma_f32_16x16x32_bf16 v[112:115], a[224:227], v[56:59], v[112:115]
v_accvgpr_write_b32 a134, 0
v_accvgpr_write_b32 a135, 0
v_mfma_f32_16x16x32_bf16 v[112:115], a[228:231], v[76:79], v[112:115]
v_accvgpr_write_b32 a136, 0
v_accvgpr_write_b32 a137, 0
v_mfma_f32_16x16x32_bf16 v[144:147], a[228:231], v[80:83], v[144:147]
v_accvgpr_write_b32 a138, 0
v_accvgpr_write_b32 a139, 0
v_mfma_f32_16x16x32_bf16 v[144:147], a[224:227], v[60:63], v[144:147]
v_accvgpr_write_b32 a140, 0
v_accvgpr_write_b32 a141, 0
v_mfma_f32_16x16x32_bf16 v[176:179], a[224:227], v[64:67], v[176:179]
v_accvgpr_write_b32 a142, 0
v_accvgpr_write_b32 a143, 0
v_mfma_f32_16x16x32_bf16 v[176:179], a[228:231], v[84:87], v[176:179]
v_accvgpr_write_b32 a144, 0
v_accvgpr_write_b32 a145, 0
v_mfma_f32_16x16x32_bf16 v[208:211], a[228:231], v[88:91], v[208:211]
v_accvgpr_write_b32 a146, 0
v_accvgpr_write_b32 a147, 0
v_mfma_f32_16x16x32_bf16 v[208:211], a[224:227], v[68:71], v[208:211]
v_accvgpr_write_b32 a148, 0
v_accvgpr_write_b32 a149, 0
v_mfma_f32_16x16x32_bf16 v[240:243], a[224:227], v[72:75], v[240:243]
v_accvgpr_write_b32 a150, 0
v_accvgpr_write_b32 a151, 0
v_mfma_f32_16x16x32_bf16 v[240:243], a[228:231], v[92:95], v[240:243]
v_accvgpr_write_b32 a152, 0
v_accvgpr_write_b32 a153, 0
v_mfma_f32_16x16x32_bf16 v[244:247], a[236:239], v[92:95], v[244:247]
v_accvgpr_write_b32 a154, 0
v_accvgpr_write_b32 a155, 0
v_mfma_f32_16x16x32_bf16 v[244:247], a[232:235], v[72:75], v[244:247]
v_accvgpr_write_b32 a156, 0
v_accvgpr_write_b32 a157, 0
v_mfma_f32_16x16x32_bf16 v[212:215], a[232:235], v[68:71], v[212:215]
v_accvgpr_write_b32 a158, 0
v_accvgpr_write_b32 a159, 0
v_mfma_f32_16x16x32_bf16 v[212:215], a[236:239], v[88:91], v[212:215]
v_accvgpr_write_b32 a160, 0
v_accvgpr_write_b32 a161, 0
v_mfma_f32_16x16x32_bf16 v[180:183], a[236:239], v[84:87], v[180:183]
v_accvgpr_write_b32 a162, 0
v_accvgpr_write_b32 a163, 0
v_mfma_f32_16x16x32_bf16 v[180:183], a[232:235], v[64:67], v[180:183]
v_accvgpr_write_b32 a164, 0
v_accvgpr_write_b32 a165, 0
v_mfma_f32_16x16x32_bf16 v[148:151], a[232:235], v[60:63], v[148:151]
v_accvgpr_write_b32 a166, 0
v_accvgpr_write_b32 a167, 0
v_mfma_f32_16x16x32_bf16 v[148:151], a[236:239], v[80:83], v[148:151]
v_accvgpr_write_b32 a168, 0
v_accvgpr_write_b32 a169, 0
v_mfma_f32_16x16x32_bf16 v[116:119], a[236:239], v[76:79], v[116:119]
v_accvgpr_write_b32 a170, 0
v_accvgpr_write_b32 a171, 0
v_mfma_f32_16x16x32_bf16 v[116:119], a[232:235], v[56:59], v[116:119]
v_accvgpr_write_b32 a172, 0
v_accvgpr_write_b32 a173, 0
v_mfma_f32_16x16x32_bf16 v[120:123], a[240:243], v[56:59], v[120:123]
v_accvgpr_write_b32 a174, 0
v_accvgpr_write_b32 a175, 0
v_mfma_f32_16x16x32_bf16 v[120:123], a[244:247], v[76:79], v[120:123]
v_accvgpr_write_b32 a176, 0
v_accvgpr_write_b32 a177, 0
v_mfma_f32_16x16x32_bf16 v[152:155], a[244:247], v[80:83], v[152:155]
v_accvgpr_write_b32 a178, 0
v_accvgpr_write_b32 a179, 0
v_mfma_f32_16x16x32_bf16 v[152:155], a[240:243], v[60:63], v[152:155]
s_lshl_b32 s28, s21, 14
v_lshrrev_b32 v1, 1, v53
v_mfma_f32_16x16x32_bf16 v[184:187], a[240:243], v[64:67], v[184:187]
v_and_b32 v3, 1, v53
v_lshl_or_b32 v1, v3, 1, v1
v_mfma_f32_16x16x32_bf16 v[184:187], a[244:247], v[84:87], v[184:187]
v_xor_b32 v1, v1, v52
v_lshlrev_b32 v3, 8, v52
v_mfma_f32_16x16x32_bf16 v[216:219], a[244:247], v[88:91], v[216:219]
v_add_u32 v3, s28, v3
v_lshl_add_u32 v23, v1, 4, v3
v_mfma_f32_16x16x32_bf16 v[216:219], a[240:243], v[68:71], v[216:219]
v_xor_b32 v24, 64, v23
v_xor_b32 v25, 128, v23
v_mfma_f32_16x16x32_bf16 v[248:251], a[240:243], v[72:75], v[248:251]
v_xor_b32 v26, 192, v23
v_add_u32 v27, 0x10000, v23
v_mfma_f32_16x16x32_bf16 v[248:251], a[244:247], v[92:95], v[248:251]
v_add_u32 v28, 0x10000, v24
v_add_u32 v29, 0x10000, v25
v_mfma_f32_16x16x32_bf16 v[252:255], a[252:255], v[92:95], v[252:255]
v_add_u32 v30, 0x10000, v26
v_mfma_f32_16x16x32_bf16 v[252:255], a[248:251], v[72:75], v[252:255]
v_mfma_f32_16x16x32_bf16 v[220:223], a[248:251], v[68:71], v[220:223]
v_mfma_f32_16x16x32_bf16 v[220:223], a[252:255], v[88:91], v[220:223]
v_mfma_f32_16x16x32_bf16 v[188:191], a[252:255], v[84:87], v[188:191]
v_mfma_f32_16x16x32_bf16 v[188:191], a[248:251], v[64:67], v[188:191]
v_mfma_f32_16x16x32_bf16 v[156:159], a[248:251], v[60:63], v[156:159]
v_mfma_f32_16x16x32_bf16 v[156:159], a[252:255], v[80:83], v[156:159]
v_mfma_f32_16x16x32_bf16 v[124:127], a[252:255], v[76:79], v[124:127]
v_mfma_f32_16x16x32_bf16 v[124:127], a[248:251], v[56:59], v[124:127]
v_cmp_eq_u32 vcc, 0, v52
v_mov_b32 v89, 0x3f803f80
s_nop 0
v_cndmask_b32 v88, 0, v89, vcc
v_mov_b32 v89, v88
v_mov_b32 v90, v88
v_mov_b32 v91, v88
v_mov_b32 v80, 0xff800000
v_mov_b32 v81, 0xff800000
v_mov_b32 v82, 0xff800000
v_mov_b32 v83, 0xff800000
v_mov_b32 v84, 0xff800000
v_mov_b32 v85, 0xff800000
v_mov_b32 v86, 0xff800000
v_mov_b32 v87, 0xff800000
v_mov_b32 v72, 0
v_mov_b32 v73, 0
v_mov_b32 v74, 0
v_mov_b32 v75, 0
v_pk_mul_f32 v[96:97], v[96:97], s[66:67]
v_pk_mul_f32 v[98:99], v[98:99], s[66:67]
v_pk_mul_f32 v[100:101], v[100:101], s[66:67]
v_pk_mul_f32 v[102:103], v[102:103], s[66:67]
v_cvt_pk_bf16_f32 v96, v96, v97
v_cvt_pk_bf16_f32 v97, v98, v99
v_cvt_pk_bf16_f32 v98, v100, v101
v_cvt_pk_bf16_f32 v99, v102, v103
v_pk_mul_f32 v[104:105], v[104:105], s[66:67]
v_pk_mul_f32 v[106:107], v[106:107], s[66:67]
v_pk_mul_f32 v[108:109], v[108:109], s[66:67]
v_pk_mul_f32 v[110:111], v[110:111], s[66:67]
v_cvt_pk_bf16_f32 v100, v104, v105
v_cvt_pk_bf16_f32 v101, v106, v107
v_cvt_pk_bf16_f32 v102, v108, v109
v_cvt_pk_bf16_f32 v103, v110, v111
v_pk_mul_f32 v[112:113], v[112:113], s[66:67]
v_pk_mul_f32 v[114:115], v[114:115], s[66:67]
v_pk_mul_f32 v[116:117], v[116:117], s[66:67]
v_pk_mul_f32 v[118:119], v[118:119], s[66:67]
v_cvt_pk_bf16_f32 v104, v112, v113
v_cvt_pk_bf16_f32 v105, v114, v115
v_cvt_pk_bf16_f32 v106, v116, v117
v_cvt_pk_bf16_f32 v107, v118, v119
v_pk_mul_f32 v[120:121], v[120:121], s[66:67]
v_pk_mul_f32 v[122:123], v[122:123], s[66:67]
v_pk_mul_f32 v[124:125], v[124:125], s[66:67]
v_pk_mul_f32 v[126:127], v[126:127], s[66:67]
v_cvt_pk_bf16_f32 v108, v120, v121
v_cvt_pk_bf16_f32 v109, v122, v123
v_cvt_pk_bf16_f32 v110, v124, v125
v_cvt_pk_bf16_f32 v111, v126, v127
v_pk_mul_f32 v[128:129], v[128:129], s[66:67]
v_pk_mul_f32 v[130:131], v[130:131], s[66:67]
v_pk_mul_f32 v[132:133], v[132:133], s[66:67]
v_pk_mul_f32 v[134:135], v[134:135], s[66:67]
v_cvt_pk_bf16_f32 v112, v128, v129
v_cvt_pk_bf16_f32 v113, v130, v131
v_cvt_pk_bf16_f32 v114, v132, v133
v_cvt_pk_bf16_f32 v115, v134, v135
v_pk_mul_f32 v[136:137], v[136:137], s[66:67]
v_pk_mul_f32 v[138:139], v[138:139], s[66:67]
v_pk_mul_f32 v[140:141], v[140:141], s[66:67]
v_pk_mul_f32 v[142:143], v[142:143], s[66:67]
v_cvt_pk_bf16_f32 v116, v136, v137
v_cvt_pk_bf16_f32 v117, v138, v139
v_cvt_pk_bf16_f32 v118, v140, v141
v_cvt_pk_bf16_f32 v119, v142, v143
v_pk_mul_f32 v[144:145], v[144:145], s[66:67]
v_pk_mul_f32 v[146:147], v[146:147], s[66:67]
v_pk_mul_f32 v[148:149], v[148:149], s[66:67]
v_pk_mul_f32 v[150:151], v[150:151], s[66:67]
v_cvt_pk_bf16_f32 v120, v144, v145
v_cvt_pk_bf16_f32 v121, v146, v147
v_cvt_pk_bf16_f32 v122, v148, v149
v_cvt_pk_bf16_f32 v123, v150, v151
v_pk_mul_f32 v[152:153], v[152:153], s[66:67]
v_pk_mul_f32 v[154:155], v[154:155], s[66:67]
v_pk_mul_f32 v[156:157], v[156:157], s[66:67]
v_pk_mul_f32 v[158:159], v[158:159], s[66:67]
v_cvt_pk_bf16_f32 v124, v152, v153
v_cvt_pk_bf16_f32 v125, v154, v155
v_cvt_pk_bf16_f32 v126, v156, v157
v_cvt_pk_bf16_f32 v127, v158, v159
v_pk_mul_f32 v[160:161], v[160:161], s[66:67]
v_pk_mul_f32 v[162:163], v[162:163], s[66:67]
v_pk_mul_f32 v[164:165], v[164:165], s[66:67]
v_pk_mul_f32 v[166:167], v[166:167], s[66:67]
v_cvt_pk_bf16_f32 v128, v160, v161
v_cvt_pk_bf16_f32 v129, v162, v163
v_cvt_pk_bf16_f32 v130, v164, v165
v_cvt_pk_bf16_f32 v131, v166, v167
v_pk_mul_f32 v[168:169], v[168:169], s[66:67]
v_pk_mul_f32 v[170:171], v[170:171], s[66:67]
v_pk_mul_f32 v[172:173], v[172:173], s[66:67]
v_pk_mul_f32 v[174:175], v[174:175], s[66:67]
v_cvt_pk_bf16_f32 v132, v168, v169
v_cvt_pk_bf16_f32 v133, v170, v171
v_cvt_pk_bf16_f32 v134, v172, v173
v_cvt_pk_bf16_f32 v135, v174, v175
v_pk_mul_f32 v[176:177], v[176:177], s[66:67]
v_pk_mul_f32 v[178:179], v[178:179], s[66:67]
v_pk_mul_f32 v[180:181], v[180:181], s[66:67]
v_pk_mul_f32 v[182:183], v[182:183], s[66:67]
v_cvt_pk_bf16_f32 v136, v176, v177
v_cvt_pk_bf16_f32 v137, v178, v179
v_cvt_pk_bf16_f32 v138, v180, v181
v_cvt_pk_bf16_f32 v139, v182, v183
v_pk_mul_f32 v[184:185], v[184:185], s[66:67]
v_pk_mul_f32 v[186:187], v[186:187], s[66:67]
v_pk_mul_f32 v[188:189], v[188:189], s[66:67]
v_pk_mul_f32 v[190:191], v[190:191], s[66:67]
v_cvt_pk_bf16_f32 v140, v184, v185
v_cvt_pk_bf16_f32 v141, v186, v187
v_cvt_pk_bf16_f32 v142, v188, v189
v_cvt_pk_bf16_f32 v143, v190, v191
v_pk_mul_f32 v[192:193], v[192:193], s[66:67]
v_pk_mul_f32 v[194:195], v[194:195], s[66:67]
v_pk_mul_f32 v[196:197], v[196:197], s[66:67]
v_pk_mul_f32 v[198:199], v[198:199], s[66:67]
v_cvt_pk_bf16_f32 v144, v192, v193
v_cvt_pk_bf16_f32 v145, v194, v195
v_cvt_pk_bf16_f32 v146, v196, v197
v_cvt_pk_bf16_f32 v147, v198, v199
v_pk_mul_f32 v[200:201], v[200:201], s[66:67]
v_pk_mul_f32 v[202:203], v[202:203], s[66:67]
v_pk_mul_f32 v[204:205], v[204:205], s[66:67]
v_pk_mul_f32 v[206:207], v[206:207], s[66:67]
v_cvt_pk_bf16_f32 v148, v200, v201
v_cvt_pk_bf16_f32 v149, v202, v203
v_cvt_pk_bf16_f32 v150, v204, v205
v_cvt_pk_bf16_f32 v151, v206, v207
v_pk_mul_f32 v[208:209], v[208:209], s[66:67]
v_pk_mul_f32 v[210:211], v[210:211], s[66:67]
v_pk_mul_f32 v[212:213], v[212:213], s[66:67]
v_pk_mul_f32 v[214:215], v[214:215], s[66:67]
v_cvt_pk_bf16_f32 v152, v208, v209
v_cvt_pk_bf16_f32 v153, v210, v211
v_cvt_pk_bf16_f32 v154, v212, v213
v_cvt_pk_bf16_f32 v155, v214, v215
v_pk_mul_f32 v[216:217], v[216:217], s[66:67]
v_pk_mul_f32 v[218:219], v[218:219], s[66:67]
v_pk_mul_f32 v[220:221], v[220:221], s[66:67]
v_pk_mul_f32 v[222:223], v[222:223], s[66:67]
v_cvt_pk_bf16_f32 v156, v216, v217
v_cvt_pk_bf16_f32 v157, v218, v219
v_cvt_pk_bf16_f32 v158, v220, v221
v_cvt_pk_bf16_f32 v159, v222, v223
v_pk_mul_f32 v[224:225], v[224:225], s[66:67]
v_pk_mul_f32 v[226:227], v[226:227], s[66:67]
v_pk_mul_f32 v[228:229], v[228:229], s[66:67]
v_pk_mul_f32 v[230:231], v[230:231], s[66:67]
v_cvt_pk_bf16_f32 v160, v224, v225
v_cvt_pk_bf16_f32 v161, v226, v227
v_cvt_pk_bf16_f32 v162, v228, v229
v_cvt_pk_bf16_f32 v163, v230, v231
v_pk_mul_f32 v[232:233], v[232:233], s[66:67]
v_pk_mul_f32 v[234:235], v[234:235], s[66:67]
v_pk_mul_f32 v[236:237], v[236:237], s[66:67]
v_pk_mul_f32 v[238:239], v[238:239], s[66:67]
v_cvt_pk_bf16_f32 v164, v232, v233
v_cvt_pk_bf16_f32 v165, v234, v235
v_cvt_pk_bf16_f32 v166, v236, v237
v_cvt_pk_bf16_f32 v167, v238, v239
v_pk_mul_f32 v[240:241], v[240:241], s[66:67]
v_pk_mul_f32 v[242:243], v[242:243], s[66:67]
v_pk_mul_f32 v[244:245], v[244:245], s[66:67]
v_pk_mul_f32 v[246:247], v[246:247], s[66:67]
v_cvt_pk_bf16_f32 v168, v240, v241
v_cvt_pk_bf16_f32 v169, v242, v243
v_cvt_pk_bf16_f32 v170, v244, v245
v_cvt_pk_bf16_f32 v171, v246, v247
v_pk_mul_f32 v[248:249], v[248:249], s[66:67]
v_pk_mul_f32 v[250:251], v[250:251], s[66:67]
v_pk_mul_f32 v[252:253], v[252:253], s[66:67]
v_pk_mul_f32 v[254:255], v[254:255], s[66:67]
v_cvt_pk_bf16_f32 v172, v248, v249
v_cvt_pk_bf16_f32 v173, v250, v251
v_cvt_pk_bf16_f32 v174, v252, v253
v_cvt_pk_bf16_f32 v175, v254, v255
s_add_u32 m0, s62, 65536
s_nop 0
buffer_load_dwordx4 v47, s[12:15], s46 offen offset:0 nt lds
buffer_load_dwordx4 v48, s[12:15], s46 offen offset:1024 nt lds
s_waitcnt vmcnt(10)
s_barrier
ds_read_b128 v[176:179], v23 offset:0
ds_read_b128 v[180:183], v24 offset:0
ds_read_b128 v[184:187], v25 offset:0
ds_read_b128 v[188:191], v26 offset:0
ds_read_b128 v[192:195], v23 offset:4096
ds_read_b128 v[196:199], v24 offset:4096
ds_read_b128 v[200:203], v25 offset:4096
ds_read_b128 v[204:207], v26 offset:4096
v_permlane16_swap_b32 v96, v98
v_permlane16_swap_b32 v97, v99
v_permlane16_swap_b32 v100, v102
v_permlane16_swap_b32 v101, v103
v_permlane16_swap_b32 v104, v106
v_permlane16_swap_b32 v105, v107
v_permlane16_swap_b32 v108, v110
v_permlane16_swap_b32 v109, v111
v_permlane16_swap_b32 v112, v114
v_permlane16_swap_b32 v113, v115
v_permlane16_swap_b32 v116, v118
v_permlane16_swap_b32 v117, v119
v_permlane16_swap_b32 v120, v122
v_permlane16_swap_b32 v121, v123
v_permlane16_swap_b32 v124, v126
v_permlane16_swap_b32 v125, v127
v_permlane16_swap_b32 v128, v130
v_permlane16_swap_b32 v129, v131
v_permlane16_swap_b32 v132, v134
v_permlane16_swap_b32 v133, v135
v_permlane16_swap_b32 v136, v138
v_permlane16_swap_b32 v137, v139
v_permlane16_swap_b32 v140, v142
v_permlane16_swap_b32 v141, v143
v_permlane16_swap_b32 v144, v146
v_permlane16_swap_b32 v145, v147
v_permlane16_swap_b32 v148, v150
v_permlane16_swap_b32 v149, v151
v_permlane16_swap_b32 v152, v154
v_permlane16_swap_b32 v153, v155
v_permlane16_swap_b32 v156, v158
v_permlane16_swap_b32 v157, v159
v_permlane16_swap_b32 v160, v162
v_permlane16_swap_b32 v161, v163
v_permlane16_swap_b32 v164, v166
v_permlane16_swap_b32 v165, v167
v_permlane16_swap_b32 v168, v170
v_permlane16_swap_b32 v169, v171
v_permlane16_swap_b32 v172, v174
v_permlane16_swap_b32 v173, v175
v_mov_b32 v240, 0
v_mov_b32 v241, 0
v_mov_b32 v242, 0
v_mov_b32 v243, 0
v_mov_b32 v244, 0
v_mov_b32 v245, 0
v_mov_b32 v246, 0
v_mov_b32 v247, 0
v_mov_b32 v248, 0
v_mov_b32 v249, 0
v_mov_b32 v250, 0
v_mov_b32 v251, 0
v_mov_b32 v252, 0
v_mov_b32 v253, 0
v_mov_b32 v254, 0
v_mov_b32 v255, 0
v_mov_b32 v92, 0
v_mov_b32 v93, 0
v_mov_b32 v94, 0
v_mov_b32 v95, 0
L_attn_go:
v_accvgpr_write_b32 a224, 0
v_accvgpr_write_b32 a225, 0
v_accvgpr_write_b32 a226, 0
v_accvgpr_write_b32 a227, 0
v_accvgpr_write_b32 a228, 0
v_accvgpr_write_b32 a229, 0
v_accvgpr_write_b32 a230, 0
v_accvgpr_write_b32 a231, 0
v_accvgpr_write_b32 a232, 0
v_accvgpr_write_b32 a233, 0
v_accvgpr_write_b32 a234, 0
v_accvgpr_write_b32 a235, 0
v_accvgpr_write_b32 a236, 0
v_accvgpr_write_b32 a237, 0
v_accvgpr_write_b32 a238, 0
v_accvgpr_write_b32 a239, 0
v_accvgpr_write_b32 a240, 0
v_accvgpr_write_b32 a241, 0
v_accvgpr_write_b32 a242, 0
v_accvgpr_write_b32 a243, 0
v_accvgpr_write_b32 a244, 0
v_accvgpr_write_b32 a245, 0
v_accvgpr_write_b32 a246, 0
v_accvgpr_write_b32 a247, 0
v_accvgpr_write_b32 a248, 0
v_accvgpr_write_b32 a249, 0
v_accvgpr_write_b32 a250, 0
v_accvgpr_write_b32 a251, 0
v_accvgpr_write_b32 a252, 0
v_accvgpr_write_b32 a253, 0
v_accvgpr_write_b32 a254, 0
v_accvgpr_write_b32 a255, 0
s_mov_b32 s65, 0
s_waitcnt lgkmcnt(0)
.p2align 3
L_attn_loop:
v_mfma_f32_16x16x32_bf16 v[56:59], v[176:179], v[96:99], v[240:243]
ds_read_b64_tr_b16 a[192:193], v31 offset:0
v_mfma_f32_16x16x32_bf16 v[56:59], v[180:183], v[100:103], v[56:59]
ds_read_b64_tr_b16 a[194:195], v31 offset:4096
v_mfma_f32_16x16x32_bf16 v[56:59], v[184:187], v[104:107], v[56:59]
s_waitcnt vmcnt(4)
buffer_load_dwordx4 v49, s[12:15], s46 offen offset:2048 nt lds
v_mfma_f32_16x16x32_bf16 v[56:59], v[188:191], v[108:111], v[56:59]
v_exp_f32 v80, v80
v_exp_f32 v81, v81
v_exp_f32 v82, v82
v_exp_f32 v83, v83
v_cvt_pk_bf16_f32 v80, v80, v81
v_mfma_f32_16x16x32_bf16 v[60:63], v[192:195], v[96:99], v[240:243]
ds_read_b64_tr_b16 a[196:197], v32 offset:0
ds_read_b64_tr_b16 a[198:199], v32 offset:4096
v_mfma_f32_16x16x32_bf16 v[60:63], v[196:199], v[100:103], v[60:63]
v_mfma_f32_16x16x32_bf16 v[60:63], v[200:203], v[104:107], v[60:63]
ds_read_b64_tr_b16 a[200:201], v33 offset:0
v_mfma_f32_16x16x32_bf16 v[60:63], v[204:207], v[108:111], v[60:63]
v_mfma_f32_16x16x32_bf16 a[96:99], a[224:227], v[72:75], a[96:99]
ds_read_b64_tr_b16 a[202:203], v33 offset:4096
v_mfma_f32_16x16x32_bf16 a[100:103], a[228:231], v[72:75], a[100:103]
ds_read_b64_tr_b16 a[204:205], v34 offset:0
v_mfma_f32_16x16x32_bf16 a[104:107], a[232:235], v[72:75], a[104:107]
v_exp_f32 v84, v84
v_exp_f32 v85, v85
v_exp_f32 v86, v86
v_exp_f32 v87, v87
v_cvt_pk_bf16_f32 v81, v82, v83
v_cvt_pk_bf16_f32 v82, v84, v85
v_mfma_f32_16x16x32_bf16 a[108:111], a[236:239], v[72:75], a[108:111]
ds_read_b64_tr_b16 a[206:207], v34 offset:4096
v_mfma_f32_16x16x32_bf16 a[112:115], a[240:243], v[72:75], a[112:115]
v_cvt_pk_bf16_f32 v83, v86, v87
v_mfma_f32_16x16x32_bf16 a[116:119], a[244:247], v[72:75], a[116:119]
ds_read_b64_tr_b16 a[208:209], v35 offset:0
s_waitcnt vmcnt(4)
buffer_load_dwordx4 v50, s[12:15], s46 offen offset:3072 nt lds
s_add_u32 m0, s62, 69632
s_add_u32 s46, s46, 65536
v_mfma_f32_16x16x32_bf16 a[120:123], a[248:251], v[72:75], a[120:123]
ds_read_b64_tr_b16 a[210:211], v35 offset:4096
v_mfma_f32_16x16x32_bf16 a[124:127], a[252:255], v[72:75], a[124:127]
v_mfma_f32_16x16x32_bf16 a[172:175], v[88:91], v[72:75], a[172:175]
ds_read_b64_tr_b16 a[212:213], v36 offset:0
v_mfma_f32_16x16x32_bf16 v[64:67], v[176:179], v[112:115], v[244:247]
ds_read_b64_tr_b16 a[214:215], v36 offset:4096
v_mfma_f32_16x16x32_bf16 v[64:67], v[180:183], v[116:119], v[64:67]
v_mfma_f32_16x16x32_bf16 v[64:67], v[184:187], v[120:123], v[64:67]
ds_read_b64_tr_b16 a[216:217], v37 offset:0
v_mfma_f32_16x16x32_bf16 v[64:67], v[188:191], v[124:127], v[64:67]
v_exp_f32 v56, v56
v_exp_f32 v57, v57
v_exp_f32 v58, v58
v_exp_f32 v59, v59
v_cvt_pk_bf16_f32 v56, v56, v57
v_mfma_f32_16x16x32_bf16 v[68:71], v[192:195], v[112:115], v[244:247]
ds_read_b64_tr_b16 a[218:219], v37 offset:4096
v_mfma_f32_16x16x32_bf16 v[68:71], v[196:199], v[116:119], v[68:71]
ds_read_b64_tr_b16 a[220:221], v38 offset:0
v_mfma_f32_16x16x32_bf16 v[68:71], v[200:203], v[120:123], v[68:71]
s_waitcnt vmcnt(4)
buffer_load_dwordx4 v47, s[12:15], s46 offen offset:0 nt lds
v_mfma_f32_16x16x32_bf16 v[68:71], v[204:207], v[124:127], v[68:71]
ds_read_b64_tr_b16 a[222:223], v38 offset:4096
v_mfma_f32_16x16x32_bf16 a[128:131], a[224:227], v[80:83], a[128:131]
v_mfma_f32_16x16x32_bf16 a[132:135], a[228:231], v[80:83], a[132:135]
v_mfma_f32_16x16x32_bf16 a[136:139], a[232:235], v[80:83], a[136:139]
v_exp_f32 v60, v60
v_exp_f32 v61, v61
v_exp_f32 v62, v62
v_exp_f32 v63, v63
v_cvt_pk_bf16_f32 v57, v58, v59
v_cvt_pk_bf16_f32 v58, v60, v61
v_mfma_f32_16x16x32_bf16 a[140:143], a[236:239], v[80:83], a[140:143]
v_mfma_f32_16x16x32_bf16 a[144:147], a[240:243], v[80:83], a[144:147]
v_cvt_pk_bf16_f32 v59, v62, v63
v_mfma_f32_16x16x32_bf16 a[148:151], a[244:247], v[80:83], a[148:151]
v_mfma_f32_16x16x32_bf16 a[152:155], a[248:251], v[80:83], a[152:155]
v_mfma_f32_16x16x32_bf16 a[156:159], a[252:255], v[80:83], a[156:159]
v_mfma_f32_16x16x32_bf16 a[176:179], v[88:91], v[80:83], a[176:179]
s_waitcnt lgkmcnt(0)
s_waitcnt vmcnt(4)
buffer_load_dwordx4 v48, s[12:15], s46 offen offset:1024 nt lds
v_mfma_f32_16x16x32_bf16 v[72:75], v[176:179], v[128:131], v[248:251]
v_mfma_f32_16x16x32_bf16 v[72:75], v[180:183], v[132:135], v[72:75]
v_mfma_f32_16x16x32_bf16 v[72:75], v[184:187], v[136:139], v[72:75]
v_mfma_f32_16x16x32_bf16 v[72:75], v[188:191], v[140:143], v[72:75]
v_exp_f32 v64, v64
v_exp_f32 v65, v65
v_exp_f32 v66, v66
v_exp_f32 v67, v67
v_cvt_pk_bf16_f32 v64, v64, v65
v_mfma_f32_16x16x32_bf16 v[76:79], v[192:195], v[128:131], v[248:251]
v_mfma_f32_16x16x32_bf16 v[76:79], v[196:199], v[132:135], v[76:79]
v_mfma_f32_16x16x32_bf16 v[76:79], v[200:203], v[136:139], v[76:79]
v_mfma_f32_16x16x32_bf16 v[76:79], v[204:207], v[140:143], v[76:79]
v_mfma_f32_16x16x32_bf16 a[0:3], a[192:195], v[56:59], a[0:3]
v_mfma_f32_16x16x32_bf16 a[4:7], a[196:199], v[56:59], a[4:7]
v_mfma_f32_16x16x32_bf16 a[8:11], a[200:203], v[56:59], a[8:11]
v_exp_f32 v68, v68
v_exp_f32 v69, v69
v_exp_f32 v70, v70
v_exp_f32 v71, v71
v_cvt_pk_bf16_f32 v65, v66, v67
v_cvt_pk_bf16_f32 v66, v68, v69
v_mfma_f32_16x16x32_bf16 a[12:15], a[204:207], v[56:59], a[12:15]
s_waitcnt vmcnt(4)
buffer_load_dwordx4 v49, s[12:15], s46 offen offset:2048 nt lds
v_mfma_f32_16x16x32_bf16 a[16:19], a[208:211], v[56:59], a[16:19]
v_cvt_pk_bf16_f32 v67, v70, v71
v_mfma_f32_16x16x32_bf16 a[20:23], a[212:215], v[56:59], a[20:23]
v_mfma_f32_16x16x32_bf16 a[24:27], a[216:219], v[56:59], a[24:27]
v_mfma_f32_16x16x32_bf16 a[28:31], a[220:223], v[56:59], a[28:31]
v_mfma_f32_16x16x32_bf16 a[160:163], v[88:91], v[56:59], a[160:163]
s_waitcnt vmcnt(7) lgkmcnt(0)
s_barrier
v_mfma_f32_16x16x32_bf16 v[80:83], v[176:179], v[144:147], v[252:255]
v_mfma_f32_16x16x32_bf16 v[80:83], v[180:183], v[148:151], v[80:83]
v_mfma_f32_16x16x32_bf16 v[80:83], v[184:187], v[152:155], v[80:83]
v_mfma_f32_16x16x32_bf16 v[80:83], v[188:191], v[156:159], v[80:83]
v_exp_f32 v72, v72
v_exp_f32 v73, v73
v_exp_f32 v74, v74
v_exp_f32 v75, v75
v_cvt_pk_bf16_f32 v72, v72, v73
v_mfma_f32_16x16x32_bf16 v[84:87], v[192:195], v[144:147], v[252:255]
s_waitcnt vmcnt(4)
buffer_load_dwordx4 v50, s[12:15], s46 offen offset:3072 nt lds
s_add_u32 m0, s62, 98304
s_or_b32 s46, s46, 0xfffdf0ff
s_add_u32 s46, s46, 1
s_and_b32 s46, s46, 0x20f00
v_mfma_f32_16x16x32_bf16 v[84:87], v[196:199], v[148:151], v[84:87]
ds_read_b128 v[208:211], v23 offset:32768
ds_read_b128 v[212:215], v24 offset:32768
v_mfma_f32_16x16x32_bf16 v[84:87], v[200:203], v[152:155], v[84:87]
v_mfma_f32_16x16x32_bf16 v[84:87], v[204:207], v[156:159], v[84:87]
v_mfma_f32_16x16x32_bf16 a[32:35], a[192:195], v[64:67], a[32:35]
ds_read_b128 v[216:219], v25 offset:32768
v_mfma_f32_16x16x32_bf16 a[36:39], a[196:199], v[64:67], a[36:39]
v_mfma_f32_16x16x32_bf16 a[40:43], a[200:203], v[64:67], a[40:43]
v_exp_f32 v76, v76
v_exp_f32 v77, v77
v_exp_f32 v78, v78
v_exp_f32 v79, v79
v_cvt_pk_bf16_f32 v73, v74, v75
v_cvt_pk_bf16_f32 v74, v76, v77
v_mfma_f32_16x16x32_bf16 a[44:47], a[204:207], v[64:67], a[44:47]
ds_read_b128 v[220:223], v26 offset:32768
v_mfma_f32_16x16x32_bf16 a[48:51], a[208:211], v[64:67], a[48:51]
v_cvt_pk_bf16_f32 v75, v78, v79
v_mfma_f32_16x16x32_bf16 a[52:55], a[212:215], v[64:67], a[52:55]
v_mfma_f32_16x16x32_bf16 a[56:59], a[216:219], v[64:67], a[56:59]
s_waitcnt vmcnt(4)
buffer_load_dwordx4 v47, s[12:15], s46 offen offset:0 nt lds
v_mfma_f32_16x16x32_bf16 a[60:63], a[220:223], v[64:67], a[60:63]
ds_read_b128 v[224:227], v23 offset:36864
v_mfma_f32_16x16x32_bf16 a[164:167], v[88:91], v[64:67], a[164:167]
ds_read_b128 v[228:231], v24 offset:36864
v_mfma_f32_16x16x32_bf16 v[56:59], v[176:179], v[160:163], v[92:95]
v_mfma_f32_16x16x32_bf16 v[56:59], v[180:183], v[164:167], v[56:59]
v_mfma_f32_16x16x32_bf16 v[56:59], v[184:187], v[168:171], v[56:59]
ds_read_b128 v[232:235], v25 offset:36864
v_mfma_f32_16x16x32_bf16 v[56:59], v[188:191], v[172:175], v[56:59]
v_exp_f32 v80, v80
v_exp_f32 v81, v81
v_exp_f32 v82, v82
v_exp_f32 v83, v83
v_cvt_pk_bf16_f32 v80, v80, v81
v_mfma_f32_16x16x32_bf16 v[60:63], v[192:195], v[160:163], v[92:95]
v_mfma_f32_16x16x32_bf16 v[60:63], v[196:199], v[164:167], v[60:63]
ds_read_b128 v[236:239], v26 offset:36864
v_mfma_f32_16x16x32_bf16 v[60:63], v[200:203], v[168:171], v[60:63]
v_mfma_f32_16x16x32_bf16 v[60:63], v[204:207], v[172:175], v[60:63]
v_mfma_f32_16x16x32_bf16 a[64:67], a[192:195], v[72:75], a[64:67]
s_waitcnt vmcnt(4)
buffer_load_dwordx4 v48, s[12:15], s46 offen offset:1024 nt lds
v_mfma_f32_16x16x32_bf16 a[68:71], a[196:199], v[72:75], a[68:71]
v_mfma_f32_16x16x32_bf16 a[72:75], a[200:203], v[72:75], a[72:75]
v_exp_f32 v84, v84
v_exp_f32 v85, v85
v_exp_f32 v86, v86
v_exp_f32 v87, v87
v_cvt_pk_bf16_f32 v81, v82, v83
v_cvt_pk_bf16_f32 v82, v84, v85
v_mfma_f32_16x16x32_bf16 a[76:79], a[204:207], v[72:75], a[76:79]
v_mfma_f32_16x16x32_bf16 a[80:83], a[208:211], v[72:75], a[80:83]
v_cvt_pk_bf16_f32 v83, v86, v87
v_mfma_f32_16x16x32_bf16 a[84:87], a[212:215], v[72:75], a[84:87]
v_mfma_f32_16x16x32_bf16 a[88:91], a[216:219], v[72:75], a[88:91]
v_mfma_f32_16x16x32_bf16 a[92:95], a[220:223], v[72:75], a[92:95]
v_mfma_f32_16x16x32_bf16 a[168:171], v[88:91], v[72:75], a[168:171]
s_waitcnt lgkmcnt(0)
v_mfma_f32_16x16x32_bf16 v[64:67], v[208:211], v[96:99], v[240:243]
ds_read_b64_tr_b16 a[224:225], v31 offset:32768
v_mfma_f32_16x16x32_bf16 v[64:67], v[212:215], v[100:103], v[64:67]
ds_read_b64_tr_b16 a[226:227], v31 offset:36864
v_mfma_f32_16x16x32_bf16 v[64:67], v[216:219], v[104:107], v[64:67]
s_waitcnt vmcnt(4)
buffer_load_dwordx4 v49, s[12:15], s46 offen offset:2048 nt lds
v_mfma_f32_16x16x32_bf16 v[64:67], v[220:223], v[108:111], v[64:67]
v_exp_f32 v56, v56
v_exp_f32 v57, v57
v_exp_f32 v58, v58
v_exp_f32 v59, v59
v_cvt_pk_bf16_f32 v56, v56, v57
v_mfma_f32_16x16x32_bf16 v[68:71], v[224:227], v[96:99], v[240:243]
ds_read_b64_tr_b16 a[228:229], v32 offset:32768
ds_read_b64_tr_b16 a[230:231], v32 offset:36864
v_mfma_f32_16x16x32_bf16 v[68:71], v[228:231], v[100:103], v[68:71]
v_mfma_f32_16x16x32_bf16 v[68:71], v[232:235], v[104:107], v[68:71]
ds_read_b64_tr_b16 a[232:233], v33 offset:32768
v_mfma_f32_16x16x32_bf16 v[68:71], v[236:239], v[108:111], v[68:71]
v_mfma_f32_16x16x32_bf16 a[96:99], a[192:195], v[80:83], a[96:99]
ds_read_b64_tr_b16 a[234:235], v33 offset:36864
v_mfma_f32_16x16x32_bf16 a[100:103], a[196:199], v[80:83], a[100:103]
ds_read_b64_tr_b16 a[236:237], v34 offset:32768
v_mfma_f32_16x16x32_bf16 a[104:107], a[200:203], v[80:83], a[104:107]
v_exp_f32 v60, v60
v_exp_f32 v61, v61
v_exp_f32 v62, v62
v_exp_f32 v63, v63
v_cvt_pk_bf16_f32 v57, v58, v59
v_cvt_pk_bf16_f32 v58, v60, v61
v_mfma_f32_16x16x32_bf16 a[108:111], a[204:207], v[80:83], a[108:111]
ds_read_b64_tr_b16 a[238:239], v34 offset:36864
v_mfma_f32_16x16x32_bf16 a[112:115], a[208:211], v[80:83], a[112:115]
v_cvt_pk_bf16_f32 v59, v62, v63
v_mfma_f32_16x16x32_bf16 a[116:119], a[212:215], v[80:83], a[116:119]
ds_read_b64_tr_b16 a[240:241], v35 offset:32768
s_waitcnt vmcnt(4)
buffer_load_dwordx4 v50, s[12:15], s46 offen offset:3072 nt lds
s_add_u32 m0, s62, 102400
s_add_u32 s46, s46, 65536
v_mfma_f32_16x16x32_bf16 a[120:123], a[216:219], v[80:83], a[120:123]
ds_read_b64_tr_b16 a[242:243], v35 offset:36864
v_mfma_f32_16x16x32_bf16 a[124:127], a[220:223], v[80:83], a[124:127]
v_mfma_f32_16x16x32_bf16 a[172:175], v[88:91], v[80:83], a[172:175]
ds_read_b64_tr_b16 a[244:245], v36 offset:32768
v_mfma_f32_16x16x32_bf16 v[72:75], v[208:211], v[112:115], v[244:247]
ds_read_b64_tr_b16 a[246:247], v36 offset:36864
v_mfma_f32_16x16x32_bf16 v[72:75], v[212:215], v[116:119], v[72:75]
v_mfma_f32_16x16x32_bf16 v[72:75], v[216:219], v[120:123], v[72:75]
ds_read_b64_tr_b16 a[248:249], v37 offset:32768
v_mfma_f32_16x16x32_bf16 v[72:75], v[220:223], v[124:127], v[72:75]
v_exp_f32 v64, v64
v_exp_f32 v65, v65
v_exp_f32 v66, v66
v_exp_f32 v67, v67
v_cvt_pk_bf16_f32 v64, v64, v65
v_mfma_f32_16x16x32_bf16 v[76:79], v[224:227], v[112:115], v[244:247]
ds_read_b64_tr_b16 a[250:251], v37 offset:36864
v_mfma_f32_16x16x32_bf16 v[76:79], v[228:231], v[116:119], v[76:79]
ds_read_b64_tr_b16 a[252:253], v38 offset:32768
v_mfma_f32_16x16x32_bf16 v[76:79], v[232:235], v[120:123], v[76:79]
s_waitcnt vmcnt(4)
buffer_load_dwordx4 v47, s[12:15], s46 offen offset:0 nt lds
v_mfma_f32_16x16x32_bf16 v[76:79], v[236:239], v[124:127], v[76:79]
ds_read_b64_tr_b16 a[254:255], v38 offset:36864
v_mfma_f32_16x16x32_bf16 a[128:131], a[192:195], v[56:59], a[128:131]
v_mfma_f32_16x16x32_bf16 a[132:135], a[196:199], v[56:59], a[132:135]
v_mfma_f32_16x16x32_bf16 a[136:139], a[200:203], v[56:59], a[136:139]
v_exp_f32 v68, v68
v_exp_f32 v69, v69
v_exp_f32 v70, v70
v_exp_f32 v71, v71
v_cvt_pk_bf16_f32 v65, v66, v67
v_cvt_pk_bf16_f32 v66, v68, v69
v_mfma_f32_16x16x32_bf16 a[140:143], a[204:207], v[56:59], a[140:143]
v_mfma_f32_16x16x32_bf16 a[144:147], a[208:211], v[56:59], a[144:147]
v_cvt_pk_bf16_f32 v67, v70, v71
v_mfma_f32_16x16x32_bf16 a[148:151], a[212:215], v[56:59], a[148:151]
v_mfma_f32_16x16x32_bf16 a[152:155], a[216:219], v[56:59], a[152:155]
v_mfma_f32_16x16x32_bf16 a[156:159], a[220:223], v[56:59], a[156:159]
v_mfma_f32_16x16x32_bf16 a[176:179], v[88:91], v[56:59], a[176:179]
s_waitcnt lgkmcnt(0)
s_waitcnt vmcnt(4)
buffer_load_dwordx4 v48, s[12:15], s46 offen offset:1024 nt lds
v_mfma_f32_16x16x32_bf16 v[80:83], v[208:211], v[128:131], v[248:251]
v_mfma_f32_16x16x32_bf16 v[80:83], v[212:215], v[132:135], v[80:83]
v_mfma_f32_16x16x32_bf16 v[80:83], v[216:219], v[136:139], v[80:83]
v_mfma_f32_16x16x32_bf16 v[80:83], v[220:223], v[140:143], v[80:83]
v_exp_f32 v72, v72
v_exp_f32 v73, v73
v_exp_f32 v74, v74
v_exp_f32 v75, v75
v_cvt_pk_bf16_f32 v72, v72, v73
v_mfma_f32_16x16x32_bf16 v[84:87], v[224:227], v[128:131], v[248:251]
v_mfma_f32_16x16x32_bf16 v[84:87], v[228:231], v[132:135], v[84:87]
v_mfma_f32_16x16x32_bf16 v[84:87], v[232:235], v[136:139], v[84:87]
v_mfma_f32_16x16x32_bf16 v[84:87], v[236:239], v[140:143], v[84:87]
v_mfma_f32_16x16x32_bf16 a[0:3], a[224:227], v[64:67], a[0:3]
v_mfma_f32_16x16x32_bf16 a[4:7], a[228:231], v[64:67], a[4:7]
v_mfma_f32_16x16x32_bf16 a[8:11], a[232:235], v[64:67], a[8:11]
v_exp_f32 v76, v76
v_exp_f32 v77, v77
v_exp_f32 v78, v78
v_exp_f32 v79, v79
v_cvt_pk_bf16_f32 v73, v74, v75
v_cvt_pk_bf16_f32 v74, v76, v77
v_mfma_f32_16x16x32_bf16 a[12:15], a[236:239], v[64:67], a[12:15]
s_waitcnt vmcnt(4)
buffer_load_dwordx4 v49, s[12:15], s46 offen offset:2048 nt lds
v_mfma_f32_16x16x32_bf16 a[16:19], a[240:243], v[64:67], a[16:19]
v_cvt_pk_bf16_f32 v75, v78, v79
v_mfma_f32_16x16x32_bf16 a[20:23], a[244:247], v[64:67], a[20:23]
v_mfma_f32_16x16x32_bf16 a[24:27], a[248:251], v[64:67], a[24:27]
v_mfma_f32_16x16x32_bf16 a[28:31], a[252:255], v[64:67], a[28:31]
v_mfma_f32_16x16x32_bf16 a[160:163], v[88:91], v[64:67], a[160:163]
s_waitcnt vmcnt(7) lgkmcnt(0)
s_barrier
v_mfma_f32_16x16x32_bf16 v[56:59], v[208:211], v[144:147], v[252:255]
v_mfma_f32_16x16x32_bf16 v[56:59], v[212:215], v[148:151], v[56:59]
v_mfma_f32_16x16x32_bf16 v[56:59], v[216:219], v[152:155], v[56:59]
v_mfma_f32_16x16x32_bf16 v[56:59], v[220:223], v[156:159], v[56:59]
v_exp_f32 v80, v80
v_exp_f32 v81, v81
v_exp_f32 v82, v82
v_exp_f32 v83, v83
v_cvt_pk_bf16_f32 v80, v80, v81
v_mfma_f32_16x16x32_bf16 v[60:63], v[224:227], v[144:147], v[252:255]
s_waitcnt vmcnt(4)
buffer_load_dwordx4 v50, s[12:15], s46 offen offset:3072 nt lds
s_add_u32 m0, s62, 0
s_or_b32 s46, s46, 0xfffdf0ff
s_add_u32 s46, s46, 1
s_and_b32 s46, s46, 0x20f00
v_mfma_f32_16x16x32_bf16 v[60:63], v[228:231], v[148:151], v[60:63]
ds_read_b128 v[176:179], v27 offset:0
ds_read_b128 v[180:183], v28 offset:0
v_mfma_f32_16x16x32_bf16 v[60:63], v[232:235], v[152:155], v[60:63]
v_mfma_f32_16x16x32_bf16 v[60:63], v[236:239], v[156:159], v[60:63]
v_mfma_f32_16x16x32_bf16 a[32:35], a[224:227], v[72:75], a[32:35]
ds_read_b128 v[184:187], v29 offset:0
v_mfma_f32_16x16x32_bf16 a[36:39], a[228:231], v[72:75], a[36:39]
v_mfma_f32_16x16x32_bf16 a[40:43], a[232:235], v[72:75], a[40:43]
v_exp_f32 v84, v84
v_exp_f32 v85, v85
v_exp_f32 v86, v86
v_exp_f32 v87, v87
v_cvt_pk_bf16_f32 v81, v82, v83
v_cvt_pk_bf16_f32 v82, v84, v85
v_mfma_f32_16x16x32_bf16 a[44:47], a[236:239], v[72:75], a[44:47]
ds_read_b128 v[188:191], v30 offset:0
v_mfma_f32_16x16x32_bf16 a[48:51], a[240:243], v[72:75], a[48:51]
v_cvt_pk_bf16_f32 v83, v86, v87
v_mfma_f32_16x16x32_bf16 a[52:55], a[244:247], v[72:75], a[52:55]
v_mfma_f32_16x16x32_bf16 a[56:59], a[248:251], v[72:75], a[56:59]
s_waitcnt vmcnt(4)
buffer_load_dwordx4 v47, s[12:15], s46 offen offset:0 nt lds
v_mfma_f32_16x16x32_bf16 a[60:63], a[252:255], v[72:75], a[60:63]
ds_read_b128 v[192:195], v27 offset:4096
v_mfma_f32_16x16x32_bf16 a[164:167], v[88:91], v[72:75], a[164:167]
ds_read_b128 v[196:199], v28 offset:4096
v_mfma_f32_16x16x32_bf16 v[64:67], v[208:211], v[160:163], v[92:95]
v_mfma_f32_16x16x32_bf16 v[64:67], v[212:215], v[164:167], v[64:67]
v_mfma_f32_16x16x32_bf16 v[64:67], v[216:219], v[168:171], v[64:67]
ds_read_b128 v[200:203], v29 offset:4096
v_mfma_f32_16x16x32_bf16 v[64:67], v[220:223], v[172:175], v[64:67]
v_exp_f32 v56, v56
v_exp_f32 v57, v57
v_exp_f32 v58, v58
v_exp_f32 v59, v59
v_cvt_pk_bf16_f32 v56, v56, v57
v_mfma_f32_16x16x32_bf16 v[68:71], v[224:227], v[160:163], v[92:95]
v_mfma_f32_16x16x32_bf16 v[68:71], v[228:231], v[164:167], v[68:71]
ds_read_b128 v[204:207], v30 offset:4096
v_mfma_f32_16x16x32_bf16 v[68:71], v[232:235], v[168:171], v[68:71]
v_mfma_f32_16x16x32_bf16 v[68:71], v[236:239], v[172:175], v[68:71]
v_mfma_f32_16x16x32_bf16 a[64:67], a[224:227], v[80:83], a[64:67]
s_waitcnt vmcnt(4)
buffer_load_dwordx4 v48, s[12:15], s46 offen offset:1024 nt lds
v_mfma_f32_16x16x32_bf16 a[68:71], a[228:231], v[80:83], a[68:71]
v_mfma_f32_16x16x32_bf16 a[72:75], a[232:235], v[80:83], a[72:75]
v_exp_f32 v60, v60
v_exp_f32 v61, v61
v_exp_f32 v62, v62
v_exp_f32 v63, v63
v_cvt_pk_bf16_f32 v57, v58, v59
v_cvt_pk_bf16_f32 v58, v60, v61
v_mfma_f32_16x16x32_bf16 a[76:79], a[236:239], v[80:83], a[76:79]
v_mfma_f32_16x16x32_bf16 a[80:83], a[240:243], v[80:83], a[80:83]
v_cvt_pk_bf16_f32 v59, v62, v63
v_mfma_f32_16x16x32_bf16 a[84:87], a[244:247], v[80:83], a[84:87]
v_mfma_f32_16x16x32_bf16 a[88:91], a[248:251], v[80:83], a[88:91]
v_mfma_f32_16x16x32_bf16 a[92:95], a[252:255], v[80:83], a[92:95]
v_mfma_f32_16x16x32_bf16 a[168:171], v[88:91], v[80:83], a[168:171]
s_waitcnt lgkmcnt(0)
v_mfma_f32_16x16x32_bf16 v[72:75], v[176:179], v[96:99], v[240:243]
ds_read_b64_tr_b16 a[192:193], v39 offset:0
v_mfma_f32_16x16x32_bf16 v[72:75], v[180:183], v[100:103], v[72:75]
ds_read_b64_tr_b16 a[194:195], v39 offset:4096
v_mfma_f32_16x16x32_bf16 v[72:75], v[184:187], v[104:107], v[72:75]
s_waitcnt vmcnt(4)
buffer_load_dwordx4 v49, s[12:15], s46 offen offset:2048 nt lds
v_mfma_f32_16x16x32_bf16 v[72:75], v[188:191], v[108:111], v[72:75]
v_exp_f32 v64, v64
v_exp_f32 v65, v65
v_exp_f32 v66, v66
v_exp_f32 v67, v67
v_cvt_pk_bf16_f32 v64, v64, v65
v_mfma_f32_16x16x32_bf16 v[76:79], v[192:195], v[96:99], v[240:243]
ds_read_b64_tr_b16 a[196:197], v40 offset:0
ds_read_b64_tr_b16 a[198:199], v40 offset:4096
v_mfma_f32_16x16x32_bf16 v[76:79], v[196:199], v[100:103], v[76:79]
v_mfma_f32_16x16x32_bf16 v[76:79], v[200:203], v[104:107], v[76:79]
ds_read_b64_tr_b16 a[200:201], v41 offset:0
v_mfma_f32_16x16x32_bf16 v[76:79], v[204:207], v[108:111], v[76:79]
v_mfma_f32_16x16x32_bf16 a[96:99], a[224:227], v[56:59], a[96:99]
ds_read_b64_tr_b16 a[202:203], v41 offset:4096
v_mfma_f32_16x16x32_bf16 a[100:103], a[228:231], v[56:59], a[100:103]
ds_read_b64_tr_b16 a[204:205], v42 offset:0
v_mfma_f32_16x16x32_bf16 a[104:107], a[232:235], v[56:59], a[104:107]
v_exp_f32 v68, v68
v_exp_f32 v69, v69
v_exp_f32 v70, v70
v_exp_f32 v71, v71
v_cvt_pk_bf16_f32 v65, v66, v67
v_cvt_pk_bf16_f32 v66, v68, v69
v_mfma_f32_16x16x32_bf16 a[108:111], a[236:239], v[56:59], a[108:111]
ds_read_b64_tr_b16 a[206:207], v42 offset:4096
v_mfma_f32_16x16x32_bf16 a[112:115], a[240:243], v[56:59], a[112:115]
v_cvt_pk_bf16_f32 v67, v70, v71
v_mfma_f32_16x16x32_bf16 a[116:119], a[244:247], v[56:59], a[116:119]
ds_read_b64_tr_b16 a[208:209], v43 offset:0
s_waitcnt vmcnt(4)
buffer_load_dwordx4 v50, s[12:15], s46 offen offset:3072 nt lds
s_add_u32 m0, s62, 4096
s_add_u32 s46, s46, 65536
v_mfma_f32_16x16x32_bf16 a[120:123], a[248:251], v[56:59], a[120:123]
ds_read_b64_tr_b16 a[210:211], v43 offset:4096
v_mfma_f32_16x16x32_bf16 a[124:127], a[252:255], v[56:59], a[124:127]
v_mfma_f32_16x16x32_bf16 a[172:175], v[88:91], v[56:59], a[172:175]
ds_read_b64_tr_b16 a[212:213], v44 offset:0
v_mfma_f32_16x16x32_bf16 v[80:83], v[176:179], v[112:115], v[244:247]
ds_read_b64_tr_b16 a[214:215], v44 offset:4096
v_mfma_f32_16x16x32_bf16 v[80:83], v[180:183], v[116:119], v[80:83]
v_mfma_f32_16x16x32_bf16 v[80:83], v[184:187], v[120:123], v[80:83]
ds_read_b64_tr_b16 a[216:217], v45 offset:0
v_mfma_f32_16x16x32_bf16 v[80:83], v[188:191], v[124:127], v[80:83]
v_exp_f32 v72, v72
v_exp_f32 v73, v73
v_exp_f32 v74, v74
v_exp_f32 v75, v75
v_cvt_pk_bf16_f32 v72, v72, v73
v_mfma_f32_16x16x32_bf16 v[84:87], v[192:195], v[112:115], v[244:247]
ds_read_b64_tr_b16 a[218:219], v45 offset:4096
v_mfma_f32_16x16x32_bf16 v[84:87], v[196:199], v[116:119], v[84:87]
ds_read_b64_tr_b16 a[220:221], v46 offset:0
v_mfma_f32_16x16x32_bf16 v[84:87], v[200:203], v[120:123], v[84:87]
s_waitcnt vmcnt(4)
buffer_load_dwordx4 v47, s[12:15], s46 offen offset:0 nt lds
v_mfma_f32_16x16x32_bf16 v[84:87], v[204:207], v[124:127], v[84:87]
ds_read_b64_tr_b16 a[222:223], v46 offset:4096
v_mfma_f32_16x16x32_bf16 a[128:131], a[224:227], v[64:67], a[128:131]
v_mfma_f32_16x16x32_bf16 a[132:135], a[228:231], v[64:67], a[132:135]
v_mfma_f32_16x16x32_bf16 a[136:139], a[232:235], v[64:67], a[136:139]
v_exp_f32 v76, v76
v_exp_f32 v77, v77
v_exp_f32 v78, v78
v_exp_f32 v79, v79
v_cvt_pk_bf16_f32 v73, v74, v75
v_cvt_pk_bf16_f32 v74, v76, v77
v_mfma_f32_16x16x32_bf16 a[140:143], a[236:239], v[64:67], a[140:143]
v_mfma_f32_16x16x32_bf16 a[144:147], a[240:243], v[64:67], a[144:147]
v_cvt_pk_bf16_f32 v75, v78, v79
v_mfma_f32_16x16x32_bf16 a[148:151], a[244:247], v[64:67], a[148:151]
v_mfma_f32_16x16x32_bf16 a[152:155], a[248:251], v[64:67], a[152:155]
v_mfma_f32_16x16x32_bf16 a[156:159], a[252:255], v[64:67], a[156:159]
v_mfma_f32_16x16x32_bf16 a[176:179], v[88:91], v[64:67], a[176:179]
s_waitcnt lgkmcnt(0)
s_waitcnt vmcnt(4)
buffer_load_dwordx4 v48, s[12:15], s46 offen offset:1024 nt lds
v_mfma_f32_16x16x32_bf16 v[56:59], v[176:179], v[128:131], v[248:251]
v_mfma_f32_16x16x32_bf16 v[56:59], v[180:183], v[132:135], v[56:59]
v_mfma_f32_16x16x32_bf16 v[56:59], v[184:187], v[136:139], v[56:59]
v_mfma_f32_16x16x32_bf16 v[56:59], v[188:191], v[140:143], v[56:59]
v_exp_f32 v80, v80
v_exp_f32 v81, v81
v_exp_f32 v82, v82
v_exp_f32 v83, v83
v_cvt_pk_bf16_f32 v80, v80, v81
v_mfma_f32_16x16x32_bf16 v[60:63], v[192:195], v[128:131], v[248:251]
v_mfma_f32_16x16x32_bf16 v[60:63], v[196:199], v[132:135], v[60:63]
v_mfma_f32_16x16x32_bf16 v[60:63], v[200:203], v[136:139], v[60:63]
v_mfma_f32_16x16x32_bf16 v[60:63], v[204:207], v[140:143], v[60:63]
v_mfma_f32_16x16x32_bf16 a[0:3], a[192:195], v[72:75], a[0:3]
v_mfma_f32_16x16x32_bf16 a[4:7], a[196:199], v[72:75], a[4:7]
v_mfma_f32_16x16x32_bf16 a[8:11], a[200:203], v[72:75], a[8:11]
v_exp_f32 v84, v84
v_exp_f32 v85, v85
v_exp_f32 v86, v86
v_exp_f32 v87, v87
v_cvt_pk_bf16_f32 v81, v82, v83
v_cvt_pk_bf16_f32 v82, v84, v85
v_mfma_f32_16x16x32_bf16 a[12:15], a[204:207], v[72:75], a[12:15]
s_waitcnt vmcnt(4)
buffer_load_dwordx4 v49, s[12:15], s46 offen offset:2048 nt lds
v_mfma_f32_16x16x32_bf16 a[16:19], a[208:211], v[72:75], a[16:19]
v_cvt_pk_bf16_f32 v83, v86, v87
v_mfma_f32_16x16x32_bf16 a[20:23], a[212:215], v[72:75], a[20:23]
v_mfma_f32_16x16x32_bf16 a[24:27], a[216:219], v[72:75], a[24:27]
v_mfma_f32_16x16x32_bf16 a[28:31], a[220:223], v[72:75], a[28:31]
v_mfma_f32_16x16x32_bf16 a[160:163], v[88:91], v[72:75], a[160:163]
s_waitcnt vmcnt(7) lgkmcnt(0)
s_barrier
v_mfma_f32_16x16x32_bf16 v[64:67], v[176:179], v[144:147], v[252:255]
v_mfma_f32_16x16x32_bf16 v[64:67], v[180:183], v[148:151], v[64:67]
v_mfma_f32_16x16x32_bf16 v[64:67], v[184:187], v[152:155], v[64:67]
v_mfma_f32_16x16x32_bf16 v[64:67], v[188:191], v[156:159], v[64:67]
v_exp_f32 v56, v56
v_exp_f32 v57, v57
v_exp_f32 v58, v58
v_exp_f32 v59, v59
v_cvt_pk_bf16_f32 v56, v56, v57
v_mfma_f32_16x16x32_bf16 v[68:71], v[192:195], v[144:147], v[252:255]
s_waitcnt vmcnt(4)
buffer_load_dwordx4 v50, s[12:15], s46 offen offset:3072 nt lds
s_add_u32 m0, s62, 32768
s_or_b32 s46, s46, 0xfffdf0ff
s_add_u32 s46, s46, 1
s_and_b32 s46, s46, 0x20f00
v_mfma_f32_16x16x32_bf16 v[68:71], v[196:199], v[148:151], v[68:71]
ds_read_b128 v[208:211], v27 offset:32768
ds_read_b128 v[212:215], v28 offset:32768
v_mfma_f32_16x16x32_bf16 v[68:71], v[200:203], v[152:155], v[68:71]
v_mfma_f32_16x16x32_bf16 v[68:71], v[204:207], v[156:159], v[68:71]
v_mfma_f32_16x16x32_bf16 a[32:35], a[192:195], v[80:83], a[32:35]
ds_read_b128 v[216:219], v29 offset:32768
v_mfma_f32_16x16x32_bf16 a[36:39], a[196:199], v[80:83], a[36:39]
v_mfma_f32_16x16x32_bf16 a[40:43], a[200:203], v[80:83], a[40:43]
v_exp_f32 v60, v60
v_exp_f32 v61, v61
v_exp_f32 v62, v62
v_exp_f32 v63, v63
v_cvt_pk_bf16_f32 v57, v58, v59
v_cvt_pk_bf16_f32 v58, v60, v61
v_mfma_f32_16x16x32_bf16 a[44:47], a[204:207], v[80:83], a[44:47]
ds_read_b128 v[220:223], v30 offset:32768
v_mfma_f32_16x16x32_bf16 a[48:51], a[208:211], v[80:83], a[48:51]
v_cvt_pk_bf16_f32 v59, v62, v63
v_mfma_f32_16x16x32_bf16 a[52:55], a[212:215], v[80:83], a[52:55]
v_mfma_f32_16x16x32_bf16 a[56:59], a[216:219], v[80:83], a[56:59]
s_waitcnt vmcnt(4)
buffer_load_dwordx4 v47, s[12:15], s46 offen offset:0 nt lds
v_mfma_f32_16x16x32_bf16 a[60:63], a[220:223], v[80:83], a[60:63]
ds_read_b128 v[224:227], v27 offset:36864
v_mfma_f32_16x16x32_bf16 a[164:167], v[88:91], v[80:83], a[164:167]
ds_read_b128 v[228:231], v28 offset:36864
v_mfma_f32_16x16x32_bf16 v[72:75], v[176:179], v[160:163], v[92:95]
v_mfma_f32_16x16x32_bf16 v[72:75], v[180:183], v[164:167], v[72:75]
v_mfma_f32_16x16x32_bf16 v[72:75], v[184:187], v[168:171], v[72:75]
ds_read_b128 v[232:235], v29 offset:36864
v_mfma_f32_16x16x32_bf16 v[72:75], v[188:191], v[172:175], v[72:75]
v_exp_f32 v64, v64
v_exp_f32 v65, v65
v_exp_f32 v66, v66
v_exp_f32 v67, v67
v_cvt_pk_bf16_f32 v64, v64, v65
v_mfma_f32_16x16x32_bf16 v[76:79], v[192:195], v[160:163], v[92:95]
v_mfma_f32_16x16x32_bf16 v[76:79], v[196:199], v[164:167], v[76:79]
ds_read_b128 v[236:239], v30 offset:36864
v_mfma_f32_16x16x32_bf16 v[76:79], v[200:203], v[168:171], v[76:79]
v_mfma_f32_16x16x32_bf16 v[76:79], v[204:207], v[172:175], v[76:79]
v_mfma_f32_16x16x32_bf16 a[64:67], a[192:195], v[56:59], a[64:67]
s_waitcnt vmcnt(4)
buffer_load_dwordx4 v48, s[12:15], s46 offen offset:1024 nt lds
v_mfma_f32_16x16x32_bf16 a[68:71], a[196:199], v[56:59], a[68:71]
v_mfma_f32_16x16x32_bf16 a[72:75], a[200:203], v[56:59], a[72:75]
v_exp_f32 v68, v68
v_exp_f32 v69, v69
v_exp_f32 v70, v70
v_exp_f32 v71, v71
v_cvt_pk_bf16_f32 v65, v66, v67
v_cvt_pk_bf16_f32 v66, v68, v69
v_mfma_f32_16x16x32_bf16 a[76:79], a[204:207], v[56:59], a[76:79]
v_mfma_f32_16x16x32_bf16 a[80:83], a[208:211], v[56:59], a[80:83]
v_cvt_pk_bf16_f32 v67, v70, v71
v_mfma_f32_16x16x32_bf16 a[84:87], a[212:215], v[56:59], a[84:87]
v_mfma_f32_16x16x32_bf16 a[88:91], a[216:219], v[56:59], a[88:91]
v_mfma_f32_16x16x32_bf16 a[92:95], a[220:223], v[56:59], a[92:95]
v_mfma_f32_16x16x32_bf16 a[168:171], v[88:91], v[56:59], a[168:171]
s_waitcnt lgkmcnt(0)
v_mfma_f32_16x16x32_bf16 v[80:83], v[208:211], v[96:99], v[240:243]
ds_read_b64_tr_b16 a[224:225], v39 offset:32768
v_mfma_f32_16x16x32_bf16 v[80:83], v[212:215], v[100:103], v[80:83]
ds_read_b64_tr_b16 a[226:227], v39 offset:36864
v_mfma_f32_16x16x32_bf16 v[80:83], v[216:219], v[104:107], v[80:83]
s_waitcnt vmcnt(4)
buffer_load_dwordx4 v49, s[12:15], s46 offen offset:2048 nt lds
v_mfma_f32_16x16x32_bf16 v[80:83], v[220:223], v[108:111], v[80:83]
v_exp_f32 v72, v72
v_exp_f32 v73, v73
v_exp_f32 v74, v74
v_exp_f32 v75, v75
v_cvt_pk_bf16_f32 v72, v72, v73
v_mfma_f32_16x16x32_bf16 v[84:87], v[224:227], v[96:99], v[240:243]
ds_read_b64_tr_b16 a[228:229], v40 offset:32768
ds_read_b64_tr_b16 a[230:231], v40 offset:36864
v_mfma_f32_16x16x32_bf16 v[84:87], v[228:231], v[100:103], v[84:87]
v_mfma_f32_16x16x32_bf16 v[84:87], v[232:235], v[104:107], v[84:87]
ds_read_b64_tr_b16 a[232:233], v41 offset:32768
v_mfma_f32_16x16x32_bf16 v[84:87], v[236:239], v[108:111], v[84:87]
v_mfma_f32_16x16x32_bf16 a[96:99], a[192:195], v[64:67], a[96:99]
ds_read_b64_tr_b16 a[234:235], v41 offset:36864
v_mfma_f32_16x16x32_bf16 a[100:103], a[196:199], v[64:67], a[100:103]
ds_read_b64_tr_b16 a[236:237], v42 offset:32768
v_mfma_f32_16x16x32_bf16 a[104:107], a[200:203], v[64:67], a[104:107]
v_exp_f32 v76, v76
v_exp_f32 v77, v77
v_exp_f32 v78, v78
v_exp_f32 v79, v79
v_cvt_pk_bf16_f32 v73, v74, v75
v_cvt_pk_bf16_f32 v74, v76, v77
v_mfma_f32_16x16x32_bf16 a[108:111], a[204:207], v[64:67], a[108:111]
ds_read_b64_tr_b16 a[238:239], v42 offset:36864
v_mfma_f32_16x16x32_bf16 a[112:115], a[208:211], v[64:67], a[112:115]
v_cvt_pk_bf16_f32 v75, v78, v79
v_mfma_f32_16x16x32_bf16 a[116:119], a[212:215], v[64:67], a[116:119]
ds_read_b64_tr_b16 a[240:241], v43 offset:32768
s_waitcnt vmcnt(4)
buffer_load_dwordx4 v50, s[12:15], s46 offen offset:3072 nt lds
s_add_u32 m0, s62, 36864
s_add_u32 s46, s46, 65536
v_mfma_f32_16x16x32_bf16 a[120:123], a[216:219], v[64:67], a[120:123]
ds_read_b64_tr_b16 a[242:243], v43 offset:36864
v_mfma_f32_16x16x32_bf16 a[124:127], a[220:223], v[64:67], a[124:127]
v_mfma_f32_16x16x32_bf16 a[172:175], v[88:91], v[64:67], a[172:175]
ds_read_b64_tr_b16 a[244:245], v44 offset:32768
v_mfma_f32_16x16x32_bf16 v[56:59], v[208:211], v[112:115], v[244:247]
ds_read_b64_tr_b16 a[246:247], v44 offset:36864
v_mfma_f32_16x16x32_bf16 v[56:59], v[212:215], v[116:119], v[56:59]
v_mfma_f32_16x16x32_bf16 v[56:59], v[216:219], v[120:123], v[56:59]
ds_read_b64_tr_b16 a[248:249], v45 offset:32768
v_mfma_f32_16x16x32_bf16 v[56:59], v[220:223], v[124:127], v[56:59]
v_exp_f32 v80, v80
v_exp_f32 v81, v81
v_exp_f32 v82, v82
v_exp_f32 v83, v83
v_cvt_pk_bf16_f32 v80, v80, v81
v_mfma_f32_16x16x32_bf16 v[60:63], v[224:227], v[112:115], v[244:247]
ds_read_b64_tr_b16 a[250:251], v45 offset:36864
v_mfma_f32_16x16x32_bf16 v[60:63], v[228:231], v[116:119], v[60:63]
ds_read_b64_tr_b16 a[252:253], v46 offset:32768
v_mfma_f32_16x16x32_bf16 v[60:63], v[232:235], v[120:123], v[60:63]
s_waitcnt vmcnt(4)
buffer_load_dwordx4 v47, s[12:15], s46 offen offset:0 nt lds
v_mfma_f32_16x16x32_bf16 v[60:63], v[236:239], v[124:127], v[60:63]
ds_read_b64_tr_b16 a[254:255], v46 offset:36864
v_mfma_f32_16x16x32_bf16 a[128:131], a[192:195], v[72:75], a[128:131]
v_mfma_f32_16x16x32_bf16 a[132:135], a[196:199], v[72:75], a[132:135]
v_mfma_f32_16x16x32_bf16 a[136:139], a[200:203], v[72:75], a[136:139]
v_exp_f32 v84, v84
v_exp_f32 v85, v85
v_exp_f32 v86, v86
v_exp_f32 v87, v87
v_cvt_pk_bf16_f32 v81, v82, v83
v_cvt_pk_bf16_f32 v82, v84, v85
v_mfma_f32_16x16x32_bf16 a[140:143], a[204:207], v[72:75], a[140:143]
v_mfma_f32_16x16x32_bf16 a[144:147], a[208:211], v[72:75], a[144:147]
v_cvt_pk_bf16_f32 v83, v86, v87
v_mfma_f32_16x16x32_bf16 a[148:151], a[212:215], v[72:75], a[148:151]
v_mfma_f32_16x16x32_bf16 a[152:155], a[216:219], v[72:75], a[152:155]
v_mfma_f32_16x16x32_bf16 a[156:159], a[220:223], v[72:75], a[156:159]
v_mfma_f32_16x16x32_bf16 a[176:179], v[88:91], v[72:75], a[176:179]
s_waitcnt lgkmcnt(0)
s_waitcnt vmcnt(4)
buffer_load_dwordx4 v48, s[12:15], s46 offen offset:1024 nt lds
v_mfma_f32_16x16x32_bf16 v[64:67], v[208:211], v[128:131], v[248:251]
v_mfma_f32_16x16x32_bf16 v[64:67], v[212:215], v[132:135], v[64:67]
v_mfma_f32_16x16x32_bf16 v[64:67], v[216:219], v[136:139], v[64:67]
v_mfma_f32_16x16x32_bf16 v[64:67], v[220:223], v[140:143], v[64:67]
v_exp_f32 v56, v56
v_exp_f32 v57, v57
v_exp_f32 v58, v58
v_exp_f32 v59, v59
v_cvt_pk_bf16_f32 v56, v56, v57
v_mfma_f32_16x16x32_bf16 v[68:71], v[224:227], v[128:131], v[248:251]
v_mfma_f32_16x16x32_bf16 v[68:71], v[228:231], v[132:135], v[68:71]
v_mfma_f32_16x16x32_bf16 v[68:71], v[232:235], v[136:139], v[68:71]
v_mfma_f32_16x16x32_bf16 v[68:71], v[236:239], v[140:143], v[68:71]
v_mfma_f32_16x16x32_bf16 a[0:3], a[224:227], v[80:83], a[0:3]
v_mfma_f32_16x16x32_bf16 a[4:7], a[228:231], v[80:83], a[4:7]
v_mfma_f32_16x16x32_bf16 a[8:11], a[232:235], v[80:83], a[8:11]
v_exp_f32 v60, v60
v_exp_f32 v61, v61
v_exp_f32 v62, v62
v_exp_f32 v63, v63
v_cvt_pk_bf16_f32 v57, v58, v59
v_cvt_pk_bf16_f32 v58, v60, v61
v_mfma_f32_16x16x32_bf16 a[12:15], a[236:239], v[80:83], a[12:15]
s_waitcnt vmcnt(4)
buffer_load_dwordx4 v49, s[12:15], s46 offen offset:2048 nt lds
v_mfma_f32_16x16x32_bf16 a[16:19], a[240:243], v[80:83], a[16:19]
v_cvt_pk_bf16_f32 v59, v62, v63
v_mfma_f32_16x16x32_bf16 a[20:23], a[244:247], v[80:83], a[20:23]
v_mfma_f32_16x16x32_bf16 a[24:27], a[248:251], v[80:83], a[24:27]
v_mfma_f32_16x16x32_bf16 a[28:31], a[252:255], v[80:83], a[28:31]
v_mfma_f32_16x16x32_bf16 a[160:163], v[88:91], v[80:83], a[160:163]
s_waitcnt vmcnt(7) lgkmcnt(0)
s_barrier
v_mfma_f32_16x16x32_bf16 v[72:75], v[208:211], v[144:147], v[252:255]
v_mfma_f32_16x16x32_bf16 v[72:75], v[212:215], v[148:151], v[72:75]
v_mfma_f32_16x16x32_bf16 v[72:75], v[216:219], v[152:155], v[72:75]
v_mfma_f32_16x16x32_bf16 v[72:75], v[220:223], v[156:159], v[72:75]
v_exp_f32 v64, v64
v_exp_f32 v65, v65
v_exp_f32 v66, v66
v_exp_f32 v67, v67
v_cvt_pk_bf16_f32 v64, v64, v65
v_mfma_f32_16x16x32_bf16 v[76:79], v[224:227], v[144:147], v[252:255]
s_waitcnt vmcnt(4)
buffer_load_dwordx4 v50, s[12:15], s46 offen offset:3072 nt lds
s_add_u32 m0, s62, 65536
s_or_b32 s46, s46, 0xfffdf0ff
s_add_u32 s46, s46, 1
s_and_b32 s46, s46, 0x20f00
v_mfma_f32_16x16x32_bf16 v[76:79], v[228:231], v[148:151], v[76:79]
ds_read_b128 v[176:179], v23 offset:0
ds_read_b128 v[180:183], v24 offset:0
v_mfma_f32_16x16x32_bf16 v[76:79], v[232:235], v[152:155], v[76:79]
v_mfma_f32_16x16x32_bf16 v[76:79], v[236:239], v[156:159], v[76:79]
v_mfma_f32_16x16x32_bf16 a[32:35], a[224:227], v[56:59], a[32:35]
ds_read_b128 v[184:187], v25 offset:0
v_mfma_f32_16x16x32_bf16 a[36:39], a[228:231], v[56:59], a[36:39]
v_mfma_f32_16x16x32_bf16 a[40:43], a[232:235], v[56:59], a[40:43]
v_exp_f32 v68, v68
v_exp_f32 v69, v69
v_exp_f32 v70, v70
v_exp_f32 v71, v71
v_cvt_pk_bf16_f32 v65, v66, v67
v_cvt_pk_bf16_f32 v66, v68, v69
v_mfma_f32_16x16x32_bf16 a[44:47], a[236:239], v[56:59], a[44:47]
ds_read_b128 v[188:191], v26 offset:0
v_mfma_f32_16x16x32_bf16 a[48:51], a[240:243], v[56:59], a[48:51]
v_cvt_pk_bf16_f32 v67, v70, v71
v_mfma_f32_16x16x32_bf16 a[52:55], a[244:247], v[56:59], a[52:55]
v_mfma_f32_16x16x32_bf16 a[56:59], a[248:251], v[56:59], a[56:59]
s_waitcnt vmcnt(4)
buffer_load_dwordx4 v47, s[12:15], s46 offen offset:0 nt lds
v_mfma_f32_16x16x32_bf16 a[60:63], a[252:255], v[56:59], a[60:63]
ds_read_b128 v[192:195], v23 offset:4096
v_mfma_f32_16x16x32_bf16 a[164:167], v[88:91], v[56:59], a[164:167]
ds_read_b128 v[196:199], v24 offset:4096
v_mfma_f32_16x16x32_bf16 v[80:83], v[208:211], v[160:163], v[92:95]
v_mfma_f32_16x16x32_bf16 v[80:83], v[212:215], v[164:167], v[80:83]
v_mfma_f32_16x16x32_bf16 v[80:83], v[216:219], v[168:171], v[80:83]
ds_read_b128 v[200:203], v25 offset:4096
v_mfma_f32_16x16x32_bf16 v[80:83], v[220:223], v[172:175], v[80:83]
v_exp_f32 v72, v72
v_exp_f32 v73, v73
v_exp_f32 v74, v74
v_exp_f32 v75, v75
v_cvt_pk_bf16_f32 v72, v72, v73
v_mfma_f32_16x16x32_bf16 v[84:87], v[224:227], v[160:163], v[92:95]
v_mfma_f32_16x16x32_bf16 v[84:87], v[228:231], v[164:167], v[84:87]
ds_read_b128 v[204:207], v26 offset:4096
v_mfma_f32_16x16x32_bf16 v[84:87], v[232:235], v[168:171], v[84:87]
v_mfma_f32_16x16x32_bf16 v[84:87], v[236:239], v[172:175], v[84:87]
v_mfma_f32_16x16x32_bf16 a[64:67], a[224:227], v[64:67], a[64:67]
s_waitcnt vmcnt(4)
buffer_load_dwordx4 v48, s[12:15], s46 offen offset:1024 nt lds
v_mfma_f32_16x16x32_bf16 a[68:71], a[228:231], v[64:67], a[68:71]
v_mfma_f32_16x16x32_bf16 a[72:75], a[232:235], v[64:67], a[72:75]
v_exp_f32 v76, v76
v_exp_f32 v77, v77
v_exp_f32 v78, v78
v_exp_f32 v79, v79
v_cvt_pk_bf16_f32 v73, v74, v75
v_cvt_pk_bf16_f32 v74, v76, v77
v_mfma_f32_16x16x32_bf16 a[76:79], a[236:239], v[64:67], a[76:79]
v_mfma_f32_16x16x32_bf16 a[80:83], a[240:243], v[64:67], a[80:83]
v_cvt_pk_bf16_f32 v75, v78, v79
v_mfma_f32_16x16x32_bf16 a[84:87], a[244:247], v[64:67], a[84:87]
v_mfma_f32_16x16x32_bf16 a[88:91], a[248:251], v[64:67], a[88:91]
v_mfma_f32_16x16x32_bf16 a[92:95], a[252:255], v[64:67], a[92:95]
v_mfma_f32_16x16x32_bf16 a[168:171], v[88:91], v[64:67], a[168:171]
s_waitcnt lgkmcnt(0)
s_add_u32 s65, s65, 1
s_cmp_lt_u32 s65, 7
s_cbranch_scc1 L_attn_loop
s_or_b32 s28, s20, s36
s_cmp_lg_u32 s28, 0
s_cbranch_scc1 L_chk_skip
v_lshrrev_b32 v3, 2, v51
s_mov_b32 s43, 0
L_init_chk:
v_cmp_le_u32 s[44:45], 4, v13
s_cmp_eq_u64 s[44:45], -1
s_cbranch_scc1 L_chk_skip
buffer_load_dword v13, v3, s[68:71], 0 offen sc1
s_add_u32 s43, s43, 1
s_waitcnt vmcnt(0)
s_cmp_lt_u32 s43, 16777216
s_cbranch_scc1 L_init_chk
L_chk_skip:
s_getpc_b64 s[56:57]
L_pcc:
s_mov_b32 s58, L_code_end-L_pcc
s_mov_b32 s59, 0x20000
v_lshrrev_b32 v1, 5, v0
s_lshr_b32 s28, s2, 3
s_lshl_b32 s28, s28, 10
v_lshlrev_b32 v1, 7, v1
buffer_load_dword a184, v1, s[56:59], s28 offen
s_mul_i32 s29, s40, 1310720
s_add_u32 s4, s16, s29
s_addc_u32 s5, s17, 0
s_mov_b32 s6, 1310720
s_bfe_u32 s24, s26, 0x10000
s_lshl_b32 s24, s24, 8
s_bfe_u32 s29, s26, 0x10001
s_lshl_b32 s29, s29, 10
s_or_b32 s24, s24, s29
s_bfe_u32 s29, s26, 0x10002
s_lshl_b32 s29, s29, 7
s_or_b32 s24, s24, s29
s_add_u32 s8, s32, s24
s_addc_u32 s9, s33, 0
s_sub_u32 s10, 8388608, s24
s_lshl_b32 s29, s21, 9
s_add_u32 s24, s24, s29
s_lshl_b32 s29, s34, 6
s_add_u32 s24, s24, s29
s_mul_i32 s47, s20, 5120
s_add_u32 s60, s47, 65536
s_lshl_b32 s61, s20, 12
s_and_b32 s28, s26, 3
s_mov_b32 s42, 52429601
s_mov_b32 s43, 34603792
s_lshl_b32 s29, s28, 4
s_lshr_b64 s[42:43], s[42:43], s29
s_and_b32 s29, s42, 0xfff
s_mul_i32 s30, s23, 0x444
s_add_u32 s29, s29, s30
s_xor_b32 s30, s23, 1
s_mul_i32 s30, s30, 0x4444
s_add_u32 s30, s30, 0x3210
s_lshl2_add_u32 s49, s23, s28
s_lshl_b32 s42, s29, 4
s_lshl_b32 s43, s30, 16
s_or_b32 s42, s42, s43
s_lshl_b32 s43, s30, 4
s_lshl_b32 s29, s29, 20
s_or_b32 s43, s43, s29
s_cmp_eq_u32 s34, 1
s_cselect_b32 s42, s43, s42
s_or_b32 s49, s49, s42
s_xor_b32 s50, s23, s34
s_lshl2_add_u32 s50, s50, s39
s_xor_b32 s51, s50, 4
s_lshl2_add_u32 s37, s34, 17
s_lshl2_add_u32 s38, s34, 13
s_mov_b32 s100, 0x9999
s_cmp_ge_u32 s23, 2
s_cselect_b32 s100, 0x6666, s100
s_bfe_u32 s29, s2, 0x20003
s_lshl_b32 s29, s29, 2
s_and_b32 s30, s2, 3
s_add_u32 s29, s29, s30
s_bitset0_b32 s100, s29
s_mov_b32 s101, 0
s_mul_i32 s41, s22, 10240
s_add_u32 s48, s41, 65536
s_lshl_b32 s28, s21, 5
s_lshl_b32 s29, s22, 3
s_add_u32 s31, s28, s29
v_add_u32 v14, s47, v51
v_add_u32 v15, s47, v51
v_add_u32 v16, s47, v51
v_add_u32 v17, s47, v51
v_add_u32 v18, 4096, v14
v_add_u32 v4, s48, v51
v_add_u32 v5, 1024, v4
v_add_u32 v6, 40960, v4
v_add_u32 v7, 40960, v5
v_add_u32 v1, s31, v53
v_lshlrev_b32 v3, 1, v53
v_xor_b32 v3, v3, v52
v_lshrrev_b32 v12, 3, v3
v_lshlrev_b32 v12, 9, v12
v_and_b32 v3, 7, v3
v_lshl_add_u32 v3, v3, 4, v12
v_lshl_add_u32 v19, v1, 11, v3
v_xor_b32 v1, 512, v19
v_add_u32 v20, 31744, v19
v_add_u32 v21, 6144, v1
v_add_u32 v22, 37888, v1
v_lshlrev_b32 v3, 2, v55
s_mov_b32 s65, 0
s_andn2_b32 s31, s65, 3
s_lshr_b32 s31, s49, s31
s_and_b32 s31, s31, 15
s_add_u32 s28, s65, s64
s_and_b32 s28, s28, 3
s_lshl2_add_u32 s28, s31, s28
s_lshl_b32 s30, s28, 17
s_mul_i32 s29, s28, 20480
s_add_u32 s65, s65, 1
s_mov_b32 s56, s30
s_andn2_b32 s31, s65, 3
s_lshr_b32 s31, s49, s31
s_and_b32 s31, s31, 15
s_add_u32 s28, s65, s64
s_and_b32 s28, s28, 3
s_lshl2_add_u32 s28, s31, s28
s_lshl_b32 s30, s28, 17
s_mul_i32 s29, s28, 20480
s_add_u32 s65, s65, 1
s_mov_b32 s57, s30
s_andn2_b32 s31, s65, 3
s_lshr_b32 s31, s49, s31
s_and_b32 s31, s31, 15
s_add_u32 s28, s65, s64
s_and_b32 s28, s28, 3
s_lshl2_add_u32 s28, s31, s28
s_lshl_b32 s30, s28, 17
s_mul_i32 s29, s28, 20480
s_add_u32 s65, s65, 1
s_mov_b32 s58, s30
s_andn2_b32 s31, s65, 3
s_lshr_b32 s31, s49, s31
s_and_b32 s31, s31, 15
s_add_u32 s28, s65, s64
s_and_b32 s28, s28, 3
s_lshl2_add_u32 s28, s31, s28
s_lshl_b32 s30, s28, 17
s_mul_i32 s29, s28, 20480
s_add_u32 s65, s65, 1
s_mov_b32 s59, s30
s_lshl_b32 s28, s40, 6
s_lshl_b32 s42, s63, 1
s_add_u32 s28, s28, s42
s_mul_i32 s28, s28, 20480
s_add_u32 s42, s41, s28
s_add_u32 s43, s42, 20480
s_mov_b32 s30, 897581056
s_mov_b32 s31, 1400897536
s_mov_b64 s[44:45], -1
s_lshl_b32 s28, s21, 1
s_sub_u32 s28, s28, s64
s_add_u32 s29, s28, 1
s_and_b32 s28, s28, 3
s_and_b32 s29, s29, 3
s_mul_i32 s28, s28, 20480
s_mul_i32 s29, s29, 20480
v_add_u32 v2, s28, v4
v_add_u32 v3, s29, v4
v_mfma_f32_16x16x32_bf16 v[56:59], v[176:179], v[96:99], v[240:243]
ds_read_b64_tr_b16 a[192:193], v31 offset:0
v_mfma_f32_16x16x32_bf16 v[56:59], v[180:183], v[100:103], v[56:59]
v_exp_f32 v80, v80
v_mfma_f32_16x16x32_bf16 v[56:59], v[184:187], v[104:107], v[56:59]
ds_read_b64_tr_b16 a[194:195], v31 offset:4096
s_waitcnt vmcnt(5)
buffer_load_dwordx4 v49, s[12:15], s46 offen offset:2048 nt lds
v_mfma_f32_16x16x32_bf16 v[56:59], v[188:191], v[108:111], v[56:59]
v_exp_f32 v81, v81
v_mfma_f32_16x16x32_bf16 v[60:63], v[192:195], v[96:99], v[240:243]
ds_read_b64_tr_b16 a[196:197], v32 offset:0
v_cvt_pk_bf16_f32 v80, v80, v81
v_mfma_f32_16x16x32_bf16 v[60:63], v[196:199], v[100:103], v[60:63]
v_exp_f32 v82, v82
v_mfma_f32_16x16x32_bf16 v[60:63], v[200:203], v[104:107], v[60:63]
ds_read_b64_tr_b16 a[198:199], v32 offset:4096
ds_read_b64_tr_b16 a[200:201], v33 offset:0
v_mfma_f32_16x16x32_bf16 v[60:63], v[204:207], v[108:111], v[60:63]
v_exp_f32 v83, v83
v_mfma_f32_16x16x32_bf16 a[96:99], a[224:227], v[72:75], a[96:99]
v_exp_f32 v84, v84
v_mfma_f32_16x16x32_bf16 a[100:103], a[228:231], v[72:75], a[100:103]
ds_read_b64_tr_b16 a[202:203], v33 offset:4096
v_cvt_pk_bf16_f32 v81, v82, v83
v_mfma_f32_16x16x32_bf16 a[104:107], a[232:235], v[72:75], a[104:107]
v_exp_f32 v85, v85
v_mfma_f32_16x16x32_bf16 a[108:111], a[236:239], v[72:75], a[108:111]
ds_read_b64_tr_b16 a[204:205], v34 offset:0
v_cvt_pk_bf16_f32 v82, v84, v85
v_mfma_f32_16x16x32_bf16 a[112:115], a[240:243], v[72:75], a[112:115]
v_exp_f32 v86, v86
v_mfma_f32_16x16x32_bf16 a[116:119], a[244:247], v[72:75], a[116:119]
ds_read_b64_tr_b16 a[206:207], v34 offset:4096
ds_read_b64_tr_b16 a[208:209], v35 offset:0
s_waitcnt vmcnt(5)
buffer_load_dwordx4 v50, s[12:15], s46 offen offset:3072 nt lds
s_add_u32 m0, s62, 69632
s_add_u32 s46, s46, 65536
v_mfma_f32_16x16x32_bf16 a[120:123], a[248:251], v[72:75], a[120:123]
v_exp_f32 v87, v87
v_mfma_f32_16x16x32_bf16 a[124:127], a[252:255], v[72:75], a[124:127]
ds_read_b64_tr_b16 a[210:211], v35 offset:4096
v_cvt_pk_bf16_f32 v83, v86, v87
v_mfma_f32_16x16x32_bf16 a[172:175], v[88:91], v[72:75], a[172:175]
ds_read_b64_tr_b16 a[212:213], v36 offset:0
v_mfma_f32_16x16x32_bf16 v[64:67], v[176:179], v[112:115], v[244:247]
ds_read_b64_tr_b16 a[214:215], v36 offset:4096
v_mfma_f32_16x16x32_bf16 v[64:67], v[180:183], v[116:119], v[64:67]
v_exp_f32 v56, v56
v_mfma_f32_16x16x32_bf16 v[64:67], v[184:187], v[120:123], v[64:67]
ds_read_b64_tr_b16 a[216:217], v37 offset:0
v_mfma_f32_16x16x32_bf16 v[64:67], v[188:191], v[124:127], v[64:67]
v_exp_f32 v57, v57
v_mfma_f32_16x16x32_bf16 v[68:71], v[192:195], v[112:115], v[244:247]
ds_read_b64_tr_b16 a[218:219], v37 offset:4096
v_cvt_pk_bf16_f32 v56, v56, v57
v_mfma_f32_16x16x32_bf16 v[68:71], v[196:199], v[116:119], v[68:71]
v_exp_f32 v58, v58
v_mfma_f32_16x16x32_bf16 v[68:71], v[200:203], v[120:123], v[68:71]
ds_read_b64_tr_b16 a[220:221], v38 offset:0
s_waitcnt vmcnt(5)
buffer_load_dwordx4 v47, s[12:15], s46 offen offset:0 nt lds
v_mfma_f32_16x16x32_bf16 v[68:71], v[204:207], v[124:127], v[68:71]
v_exp_f32 v59, v59
v_mfma_f32_16x16x32_bf16 a[128:131], a[224:227], v[80:83], a[128:131]
v_exp_f32 v60, v60
v_mfma_f32_16x16x32_bf16 a[132:135], a[228:231], v[80:83], a[132:135]
ds_read_b64_tr_b16 a[222:223], v38 offset:4096
v_cvt_pk_bf16_f32 v57, v58, v59
v_mfma_f32_16x16x32_bf16 a[136:139], a[232:235], v[80:83], a[136:139]
v_exp_f32 v61, v61
v_mfma_f32_16x16x32_bf16 a[140:143], a[236:239], v[80:83], a[140:143]
v_cvt_pk_bf16_f32 v58, v60, v61
v_mfma_f32_16x16x32_bf16 a[144:147], a[240:243], v[80:83], a[144:147]
v_exp_f32 v62, v62
v_mfma_f32_16x16x32_bf16 a[148:151], a[244:247], v[80:83], a[148:151]
v_mfma_f32_16x16x32_bf16 a[152:155], a[248:251], v[80:83], a[152:155]
v_exp_f32 v63, v63
v_mfma_f32_16x16x32_bf16 a[156:159], a[252:255], v[80:83], a[156:159]
v_cvt_pk_bf16_f32 v59, v62, v63
v_mfma_f32_16x16x32_bf16 a[176:179], v[88:91], v[80:83], a[176:179]
s_waitcnt lgkmcnt(0)
s_waitcnt vmcnt(5)
buffer_load_dwordx4 v48, s[12:15], s46 offen offset:1024 nt lds
v_mfma_f32_16x16x32_bf16 v[72:75], v[176:179], v[128:131], v[248:251]
v_mfma_f32_16x16x32_bf16 v[72:75], v[180:183], v[132:135], v[72:75]
v_exp_f32 v64, v64
v_mfma_f32_16x16x32_bf16 v[72:75], v[184:187], v[136:139], v[72:75]
v_mfma_f32_16x16x32_bf16 v[72:75], v[188:191], v[140:143], v[72:75]
v_exp_f32 v65, v65
v_mfma_f32_16x16x32_bf16 v[76:79], v[192:195], v[128:131], v[248:251]
v_cvt_pk_bf16_f32 v64, v64, v65
v_mfma_f32_16x16x32_bf16 v[76:79], v[196:199], v[132:135], v[76:79]
v_exp_f32 v66, v66
v_mfma_f32_16x16x32_bf16 v[76:79], v[200:203], v[136:139], v[76:79]
v_mfma_f32_16x16x32_bf16 v[76:79], v[204:207], v[140:143], v[76:79]
v_exp_f32 v67, v67
v_mfma_f32_16x16x32_bf16 a[0:3], a[192:195], v[56:59], a[0:3]
v_exp_f32 v68, v68
v_mfma_f32_16x16x32_bf16 a[4:7], a[196:199], v[56:59], a[4:7]
v_cvt_pk_bf16_f32 v65, v66, v67
v_mfma_f32_16x16x32_bf16 a[8:11], a[200:203], v[56:59], a[8:11]
v_exp_f32 v69, v69
v_mfma_f32_16x16x32_bf16 a[12:15], a[204:207], v[56:59], a[12:15]
s_waitcnt vmcnt(5)
buffer_load_dwordx4 v49, s[12:15], s46 offen offset:2048 nt lds
v_cvt_pk_bf16_f32 v66, v68, v69
v_mfma_f32_16x16x32_bf16 a[16:19], a[208:211], v[56:59], a[16:19]
v_exp_f32 v70, v70
v_mfma_f32_16x16x32_bf16 a[20:23], a[212:215], v[56:59], a[20:23]
v_mfma_f32_16x16x32_bf16 a[24:27], a[216:219], v[56:59], a[24:27]
v_exp_f32 v71, v71
v_mfma_f32_16x16x32_bf16 a[28:31], a[220:223], v[56:59], a[28:31]
v_cvt_pk_bf16_f32 v67, v70, v71
v_mfma_f32_16x16x32_bf16 a[160:163], v[88:91], v[56:59], a[160:163]
s_waitcnt vmcnt(7) lgkmcnt(0)
s_barrier
v_mfma_f32_16x16x32_bf16 v[80:83], v[176:179], v[144:147], v[252:255]
v_mfma_f32_16x16x32_bf16 v[80:83], v[180:183], v[148:151], v[80:83]
v_exp_f32 v72, v72
v_mfma_f32_16x16x32_bf16 v[80:83], v[184:187], v[152:155], v[80:83]
v_mfma_f32_16x16x32_bf16 v[80:83], v[188:191], v[156:159], v[80:83]
v_exp_f32 v73, v73
v_mfma_f32_16x16x32_bf16 v[84:87], v[192:195], v[144:147], v[252:255]
s_waitcnt vmcnt(5)
buffer_load_dwordx4 v50, s[12:15], s46 offen offset:3072 nt lds
s_add_u32 m0, s62, 98304
s_or_b32 s46, s46, 0xfffdf0ff
s_add_u32 s46, s46, 1
s_and_b32 s46, s46, 0x20f00
v_cvt_pk_bf16_f32 v72, v72, v73
v_mfma_f32_16x16x32_bf16 v[84:87], v[196:199], v[148:151], v[84:87]
v_exp_f32 v74, v74
v_mfma_f32_16x16x32_bf16 v[84:87], v[200:203], v[152:155], v[84:87]
ds_read_b128 v[208:211], v23 offset:32768
ds_read_b128 v[212:215], v24 offset:32768
v_mfma_f32_16x16x32_bf16 v[84:87], v[204:207], v[156:159], v[84:87]
v_exp_f32 v75, v75
v_mfma_f32_16x16x32_bf16 a[32:35], a[192:195], v[64:67], a[32:35]
v_exp_f32 v76, v76
v_mfma_f32_16x16x32_bf16 a[36:39], a[196:199], v[64:67], a[36:39]
ds_read_b128 v[216:219], v25 offset:32768
v_cvt_pk_bf16_f32 v73, v74, v75
v_mfma_f32_16x16x32_bf16 a[40:43], a[200:203], v[64:67], a[40:43]
v_exp_f32 v77, v77
v_mfma_f32_16x16x32_bf16 a[44:47], a[204:207], v[64:67], a[44:47]
ds_read_b128 v[220:223], v26 offset:32768
v_cvt_pk_bf16_f32 v74, v76, v77
v_mfma_f32_16x16x32_bf16 a[48:51], a[208:211], v[64:67], a[48:51]
v_exp_f32 v78, v78
v_mfma_f32_16x16x32_bf16 a[52:55], a[212:215], v[64:67], a[52:55]
v_mfma_f32_16x16x32_bf16 a[56:59], a[216:219], v[64:67], a[56:59]
v_exp_f32 v79, v79
v_mfma_f32_16x16x32_bf16 a[60:63], a[220:223], v[64:67], a[60:63]
s_waitcnt vmcnt(5)
buffer_load_dwordx4 v47, s[12:15], s46 offen offset:0 nt lds
v_cvt_pk_bf16_f32 v75, v78, v79
v_mfma_f32_16x16x32_bf16 a[164:167], v[88:91], v[64:67], a[164:167]
ds_read_b128 v[224:227], v23 offset:36864
ds_read_b128 v[228:231], v24 offset:36864
v_mfma_f32_16x16x32_bf16 v[56:59], v[176:179], v[160:163], v[92:95]
v_mfma_f32_16x16x32_bf16 v[56:59], v[180:183], v[164:167], v[56:59]
v_exp_f32 v80, v80
v_mfma_f32_16x16x32_bf16 v[56:59], v[184:187], v[168:171], v[56:59]
ds_read_b128 v[232:235], v25 offset:36864
v_mfma_f32_16x16x32_bf16 v[56:59], v[188:191], v[172:175], v[56:59]
v_exp_f32 v81, v81
v_mfma_f32_16x16x32_bf16 v[60:63], v[192:195], v[160:163], v[92:95]
v_cvt_pk_bf16_f32 v80, v80, v81
v_mfma_f32_16x16x32_bf16 v[60:63], v[196:199], v[164:167], v[60:63]
v_exp_f32 v82, v82
v_mfma_f32_16x16x32_bf16 v[60:63], v[200:203], v[168:171], v[60:63]
ds_read_b128 v[236:239], v26 offset:36864
v_mfma_f32_16x16x32_bf16 v[60:63], v[204:207], v[172:175], v[60:63]
v_exp_f32 v83, v83
v_mfma_f32_16x16x32_bf16 a[64:67], a[192:195], v[72:75], a[64:67]
v_exp_f32 v84, v84
v_mfma_f32_16x16x32_bf16 a[68:71], a[196:199], v[72:75], a[68:71]
s_waitcnt vmcnt(5)
buffer_load_dwordx4 v48, s[12:15], s46 offen offset:1024 nt lds
v_cvt_pk_bf16_f32 v81, v82, v83
v_mfma_f32_16x16x32_bf16 a[72:75], a[200:203], v[72:75], a[72:75]
v_exp_f32 v85, v85
v_mfma_f32_16x16x32_bf16 a[76:79], a[204:207], v[72:75], a[76:79]
v_cvt_pk_bf16_f32 v82, v84, v85
v_mfma_f32_16x16x32_bf16 a[80:83], a[208:211], v[72:75], a[80:83]
v_exp_f32 v86, v86
v_mfma_f32_16x16x32_bf16 a[84:87], a[212:215], v[72:75], a[84:87]
v_mfma_f32_16x16x32_bf16 a[88:91], a[216:219], v[72:75], a[88:91]
v_exp_f32 v87, v87
v_mfma_f32_16x16x32_bf16 a[92:95], a[220:223], v[72:75], a[92:95]
v_cvt_pk_bf16_f32 v83, v86, v87
v_mfma_f32_16x16x32_bf16 a[168:171], v[88:91], v[72:75], a[168:171]
s_waitcnt lgkmcnt(0)
v_mfma_f32_16x16x32_bf16 v[64:67], v[208:211], v[96:99], v[240:243]
ds_read_b64_tr_b16 a[224:225], v31 offset:32768
v_mfma_f32_16x16x32_bf16 v[64:67], v[212:215], v[100:103], v[64:67]
v_exp_f32 v56, v56
v_mfma_f32_16x16x32_bf16 v[64:67], v[216:219], v[104:107], v[64:67]
ds_read_b64_tr_b16 a[226:227], v31 offset:36864
s_waitcnt vmcnt(5)
buffer_load_dwordx4 v49, s[12:15], s46 offen offset:2048 nt lds
v_mfma_f32_16x16x32_bf16 v[64:67], v[220:223], v[108:111], v[64:67]
v_exp_f32 v57, v57
v_mfma_f32_16x16x32_bf16 v[68:71], v[224:227], v[96:99], v[240:243]
ds_read_b64_tr_b16 a[228:229], v32 offset:32768
v_cvt_pk_bf16_f32 v56, v56, v57
v_mfma_f32_16x16x32_bf16 v[68:71], v[228:231], v[100:103], v[68:71]
v_exp_f32 v58, v58
v_mfma_f32_16x16x32_bf16 v[68:71], v[232:235], v[104:107], v[68:71]
ds_read_b64_tr_b16 a[230:231], v32 offset:36864
ds_read_b64_tr_b16 a[232:233], v33 offset:32768
v_mfma_f32_16x16x32_bf16 v[68:71], v[236:239], v[108:111], v[68:71]
v_exp_f32 v59, v59
v_mfma_f32_16x16x32_bf16 a[96:99], a[192:195], v[80:83], a[96:99]
v_exp_f32 v60, v60
v_mfma_f32_16x16x32_bf16 a[100:103], a[196:199], v[80:83], a[100:103]
ds_read_b64_tr_b16 a[234:235], v33 offset:36864
v_cvt_pk_bf16_f32 v57, v58, v59
v_mfma_f32_16x16x32_bf16 a[104:107], a[200:203], v[80:83], a[104:107]
v_exp_f32 v61, v61
v_mfma_f32_16x16x32_bf16 a[108:111], a[204:207], v[80:83], a[108:111]
ds_read_b64_tr_b16 a[236:237], v34 offset:32768
v_cvt_pk_bf16_f32 v58, v60, v61
v_mfma_f32_16x16x32_bf16 a[112:115], a[208:211], v[80:83], a[112:115]
v_exp_f32 v62, v62
v_mfma_f32_16x16x32_bf16 a[116:119], a[212:215], v[80:83], a[116:119]
ds_read_b64_tr_b16 a[238:239], v34 offset:36864
ds_read_b64_tr_b16 a[240:241], v35 offset:32768
s_waitcnt vmcnt(5)
buffer_load_dwordx4 v50, s[12:15], s46 offen offset:3072 nt lds
s_add_u32 m0, s62, 102400
s_add_u32 s46, s46, 65536
v_mfma_f32_16x16x32_bf16 a[120:123], a[216:219], v[80:83], a[120:123]
v_exp_f32 v63, v63
v_mfma_f32_16x16x32_bf16 a[124:127], a[220:223], v[80:83], a[124:127]
ds_read_b64_tr_b16 a[242:243], v35 offset:36864
v_cvt_pk_bf16_f32 v59, v62, v63
v_mfma_f32_16x16x32_bf16 a[172:175], v[88:91], v[80:83], a[172:175]
ds_read_b64_tr_b16 a[244:245], v36 offset:32768
v_mfma_f32_16x16x32_bf16 v[72:75], v[208:211], v[112:115], v[244:247]
ds_read_b64_tr_b16 a[246:247], v36 offset:36864
v_mfma_f32_16x16x32_bf16 v[72:75], v[212:215], v[116:119], v[72:75]
v_exp_f32 v64, v64
v_mfma_f32_16x16x32_bf16 v[72:75], v[216:219], v[120:123], v[72:75]
ds_read_b64_tr_b16 a[248:249], v37 offset:32768
v_mfma_f32_16x16x32_bf16 v[72:75], v[220:223], v[124:127], v[72:75]
v_exp_f32 v65, v65
v_mfma_f32_16x16x32_bf16 v[76:79], v[224:227], v[112:115], v[244:247]
ds_read_b64_tr_b16 a[250:251], v37 offset:36864
v_cvt_pk_bf16_f32 v64, v64, v65
v_mfma_f32_16x16x32_bf16 v[76:79], v[228:231], v[116:119], v[76:79]
v_exp_f32 v66, v66
v_mfma_f32_16x16x32_bf16 v[76:79], v[232:235], v[120:123], v[76:79]
ds_read_b64_tr_b16 a[252:253], v38 offset:32768
s_waitcnt vmcnt(5)
buffer_load_dwordx4 v47, s[12:15], s46 offen offset:0 nt lds
v_mfma_f32_16x16x32_bf16 v[76:79], v[236:239], v[124:127], v[76:79]
v_exp_f32 v67, v67
v_mfma_f32_16x16x32_bf16 a[128:131], a[192:195], v[56:59], a[128:131]
v_exp_f32 v68, v68
v_mfma_f32_16x16x32_bf16 a[132:135], a[196:199], v[56:59], a[132:135]
ds_read_b64_tr_b16 a[254:255], v38 offset:36864
v_cvt_pk_bf16_f32 v65, v66, v67
v_mfma_f32_16x16x32_bf16 a[136:139], a[200:203], v[56:59], a[136:139]
v_exp_f32 v69, v69
v_mfma_f32_16x16x32_bf16 a[140:143], a[204:207], v[56:59], a[140:143]
v_cvt_pk_bf16_f32 v66, v68, v69
v_mfma_f32_16x16x32_bf16 a[144:147], a[208:211], v[56:59], a[144:147]
v_exp_f32 v70, v70
v_mfma_f32_16x16x32_bf16 a[148:151], a[212:215], v[56:59], a[148:151]
v_mfma_f32_16x16x32_bf16 a[152:155], a[216:219], v[56:59], a[152:155]
v_exp_f32 v71, v71
v_mfma_f32_16x16x32_bf16 a[156:159], a[220:223], v[56:59], a[156:159]
v_cvt_pk_bf16_f32 v67, v70, v71
v_mfma_f32_16x16x32_bf16 a[176:179], v[88:91], v[56:59], a[176:179]
s_waitcnt lgkmcnt(0)
s_waitcnt vmcnt(5)
buffer_load_dwordx4 v48, s[12:15], s46 offen offset:1024 nt lds
v_mfma_f32_16x16x32_bf16 v[80:83], v[208:211], v[128:131], v[248:251]
v_mfma_f32_16x16x32_bf16 v[80:83], v[212:215], v[132:135], v[80:83]
v_exp_f32 v72, v72
v_mfma_f32_16x16x32_bf16 v[80:83], v[216:219], v[136:139], v[80:83]
v_mfma_f32_16x16x32_bf16 v[80:83], v[220:223], v[140:143], v[80:83]
v_exp_f32 v73, v73
v_mfma_f32_16x16x32_bf16 v[84:87], v[224:227], v[128:131], v[248:251]
v_cvt_pk_bf16_f32 v72, v72, v73
v_mfma_f32_16x16x32_bf16 v[84:87], v[228:231], v[132:135], v[84:87]
v_exp_f32 v74, v74
v_mfma_f32_16x16x32_bf16 v[84:87], v[232:235], v[136:139], v[84:87]
v_mfma_f32_16x16x32_bf16 v[84:87], v[236:239], v[140:143], v[84:87]
v_exp_f32 v75, v75
v_mfma_f32_16x16x32_bf16 a[0:3], a[224:227], v[64:67], a[0:3]
v_exp_f32 v76, v76
v_mfma_f32_16x16x32_bf16 a[4:7], a[228:231], v[64:67], a[4:7]
v_cvt_pk_bf16_f32 v73, v74, v75
v_mfma_f32_16x16x32_bf16 a[8:11], a[232:235], v[64:67], a[8:11]
v_exp_f32 v77, v77
v_mfma_f32_16x16x32_bf16 a[12:15], a[236:239], v[64:67], a[12:15]
s_waitcnt vmcnt(5)
buffer_load_dwordx4 v49, s[12:15], s46 offen offset:2048 nt lds
v_cvt_pk_bf16_f32 v74, v76, v77
v_mfma_f32_16x16x32_bf16 a[16:19], a[240:243], v[64:67], a[16:19]
v_exp_f32 v78, v78
v_mfma_f32_16x16x32_bf16 a[20:23], a[244:247], v[64:67], a[20:23]
v_mfma_f32_16x16x32_bf16 a[24:27], a[248:251], v[64:67], a[24:27]
v_exp_f32 v79, v79
v_mfma_f32_16x16x32_bf16 a[28:31], a[252:255], v[64:67], a[28:31]
v_cvt_pk_bf16_f32 v75, v78, v79
v_mfma_f32_16x16x32_bf16 a[160:163], v[88:91], v[64:67], a[160:163]
s_waitcnt vmcnt(7) lgkmcnt(0)
s_barrier
v_mfma_f32_16x16x32_bf16 v[56:59], v[208:211], v[144:147], v[252:255]
v_mfma_f32_16x16x32_bf16 v[56:59], v[212:215], v[148:151], v[56:59]
v_exp_f32 v80, v80
v_mfma_f32_16x16x32_bf16 v[56:59], v[216:219], v[152:155], v[56:59]
v_mfma_f32_16x16x32_bf16 v[56:59], v[220:223], v[156:159], v[56:59]
v_exp_f32 v81, v81
v_mfma_f32_16x16x32_bf16 v[60:63], v[224:227], v[144:147], v[252:255]
s_waitcnt vmcnt(5)
buffer_load_dwordx4 v50, s[12:15], s46 offen offset:3072 nt lds
s_add_u32 m0, s62, 0
s_or_b32 s46, s46, 0xfffdf0ff
s_add_u32 s46, s46, 1
s_and_b32 s46, s46, 0x20f00
v_cvt_pk_bf16_f32 v80, v80, v81
v_mfma_f32_16x16x32_bf16 v[60:63], v[228:231], v[148:151], v[60:63]
v_exp_f32 v82, v82
v_mfma_f32_16x16x32_bf16 v[60:63], v[232:235], v[152:155], v[60:63]
ds_read_b128 v[176:179], v27 offset:0
ds_read_b128 v[180:183], v28 offset:0
v_mfma_f32_16x16x32_bf16 v[60:63], v[236:239], v[156:159], v[60:63]
v_exp_f32 v83, v83
v_mfma_f32_16x16x32_bf16 a[32:35], a[224:227], v[72:75], a[32:35]
v_exp_f32 v84, v84
v_mfma_f32_16x16x32_bf16 a[36:39], a[228:231], v[72:75], a[36:39]
ds_read_b128 v[184:187], v29 offset:0
v_cvt_pk_bf16_f32 v81, v82, v83
v_mfma_f32_16x16x32_bf16 a[40:43], a[232:235], v[72:75], a[40:43]
v_exp_f32 v85, v85
v_mfma_f32_16x16x32_bf16 a[44:47], a[236:239], v[72:75], a[44:47]
ds_read_b128 v[188:191], v30 offset:0
v_cvt_pk_bf16_f32 v82, v84, v85
v_mfma_f32_16x16x32_bf16 a[48:51], a[240:243], v[72:75], a[48:51]
v_exp_f32 v86, v86
v_mfma_f32_16x16x32_bf16 a[52:55], a[244:247], v[72:75], a[52:55]
v_mfma_f32_16x16x32_bf16 a[56:59], a[248:251], v[72:75], a[56:59]
v_exp_f32 v87, v87
v_mfma_f32_16x16x32_bf16 a[60:63], a[252:255], v[72:75], a[60:63]
s_add_u32 m0, s61, 0
v_cvt_pk_bf16_f32 v83, v86, v87
v_mfma_f32_16x16x32_bf16 a[164:167], v[88:91], v[72:75], a[164:167]
buffer_load_dwordx4 v19, s[8:11], s56 offen offset:0 lds
ds_read_b128 v[192:195], v27 offset:4096
v_mfma_f32_16x16x32_bf16 v[64:67], v[208:211], v[160:163], v[92:95]
ds_read_b128 v[196:199], v28 offset:4096
v_mfma_f32_16x16x32_bf16 v[64:67], v[212:215], v[164:167], v[64:67]
v_exp_f32 v56, v56
v_mfma_f32_16x16x32_bf16 v[64:67], v[216:219], v[168:171], v[64:67]
ds_read_b128 v[200:203], v29 offset:4096
v_mfma_f32_16x16x32_bf16 v[64:67], v[220:223], v[172:175], v[64:67]
v_exp_f32 v57, v57
v_mfma_f32_16x16x32_bf16 v[68:71], v[224:227], v[160:163], v[92:95]
v_cvt_pk_bf16_f32 v56, v56, v57
v_mfma_f32_16x16x32_bf16 v[68:71], v[228:231], v[164:167], v[68:71]
v_exp_f32 v58, v58
v_mfma_f32_16x16x32_bf16 v[68:71], v[232:235], v[168:171], v[68:71]
ds_read_b128 v[204:207], v30 offset:4096
v_mfma_f32_16x16x32_bf16 v[68:71], v[236:239], v[172:175], v[68:71]
v_exp_f32 v59, v59
v_mfma_f32_16x16x32_bf16 a[64:67], a[224:227], v[80:83], a[64:67]
v_exp_f32 v60, v60
v_mfma_f32_16x16x32_bf16 a[68:71], a[228:231], v[80:83], a[68:71]
buffer_load_dwordx4 v20, s[8:11], s56 offen offset:1024 lds
v_cvt_pk_bf16_f32 v57, v58, v59
v_mfma_f32_16x16x32_bf16 a[72:75], a[232:235], v[80:83], a[72:75]
v_exp_f32 v61, v61
v_mfma_f32_16x16x32_bf16 a[76:79], a[236:239], v[80:83], a[76:79]
v_cvt_pk_bf16_f32 v58, v60, v61
v_mfma_f32_16x16x32_bf16 a[80:83], a[240:243], v[80:83], a[80:83]
v_exp_f32 v62, v62
v_mfma_f32_16x16x32_bf16 a[84:87], a[244:247], v[80:83], a[84:87]
v_mfma_f32_16x16x32_bf16 a[88:91], a[248:251], v[80:83], a[88:91]
v_exp_f32 v63, v63
v_mfma_f32_16x16x32_bf16 a[92:95], a[252:255], v[80:83], a[92:95]
v_cvt_pk_bf16_f32 v59, v62, v63
v_mfma_f32_16x16x32_bf16 a[168:171], v[88:91], v[80:83], a[168:171]
s_waitcnt lgkmcnt(0)
v_mfma_f32_16x16x32_bf16 v[72:75], v[176:179], v[96:99], v[240:243]
ds_read_b64_tr_b16 a[192:193], v39 offset:0
v_mfma_f32_16x16x32_bf16 v[72:75], v[180:183], v[100:103], v[72:75]
v_exp_f32 v64, v64
v_mfma_f32_16x16x32_bf16 v[72:75], v[184:187], v[104:107], v[72:75]
ds_read_b64_tr_b16 a[194:195], v39 offset:4096
buffer_load_dwordx4 v21, s[8:11], s56 offen offset:2048 lds
v_mfma_f32_16x16x32_bf16 v[72:75], v[188:191], v[108:111], v[72:75]
v_exp_f32 v65, v65
v_mfma_f32_16x16x32_bf16 v[76:79], v[192:195], v[96:99], v[240:243]
ds_read_b64_tr_b16 a[196:197], v40 offset:0
v_cvt_pk_bf16_f32 v64, v64, v65
v_mfma_f32_16x16x32_bf16 v[76:79], v[196:199], v[100:103], v[76:79]
v_exp_f32 v66, v66
v_mfma_f32_16x16x32_bf16 v[76:79], v[200:203], v[104:107], v[76:79]
ds_read_b64_tr_b16 a[198:199], v40 offset:4096
ds_read_b64_tr_b16 a[200:201], v41 offset:0
v_mfma_f32_16x16x32_bf16 v[76:79], v[204:207], v[108:111], v[76:79]
v_exp_f32 v67, v67
v_mfma_f32_16x16x32_bf16 a[96:99], a[224:227], v[56:59], a[96:99]
v_exp_f32 v68, v68
v_mfma_f32_16x16x32_bf16 a[100:103], a[228:231], v[56:59], a[100:103]
ds_read_b64_tr_b16 a[202:203], v41 offset:4096
v_cvt_pk_bf16_f32 v65, v66, v67
v_mfma_f32_16x16x32_bf16 a[104:107], a[232:235], v[56:59], a[104:107]
v_exp_f32 v69, v69
v_mfma_f32_16x16x32_bf16 a[108:111], a[236:239], v[56:59], a[108:111]
ds_read_b64_tr_b16 a[204:205], v42 offset:0
v_cvt_pk_bf16_f32 v66, v68, v69
v_mfma_f32_16x16x32_bf16 a[112:115], a[240:243], v[56:59], a[112:115]
v_exp_f32 v70, v70
v_mfma_f32_16x16x32_bf16 a[116:119], a[244:247], v[56:59], a[116:119]
ds_read_b64_tr_b16 a[206:207], v42 offset:4096
ds_read_b64_tr_b16 a[208:209], v43 offset:0
buffer_load_dwordx4 v22, s[8:11], s56 offen offset:3072 lds
v_mfma_f32_16x16x32_bf16 a[120:123], a[248:251], v[56:59], a[120:123]
v_exp_f32 v71, v71
v_mfma_f32_16x16x32_bf16 a[124:127], a[252:255], v[56:59], a[124:127]
ds_read_b64_tr_b16 a[210:211], v43 offset:4096
v_cvt_pk_bf16_f32 v67, v70, v71
v_mfma_f32_16x16x32_bf16 a[172:175], v[88:91], v[56:59], a[172:175]
ds_read_b64_tr_b16 a[212:213], v44 offset:0
v_mfma_f32_16x16x32_bf16 v[80:83], v[176:179], v[112:115], v[244:247]
ds_read_b64_tr_b16 a[214:215], v44 offset:4096
v_mfma_f32_16x16x32_bf16 v[80:83], v[180:183], v[116:119], v[80:83]
v_exp_f32 v72, v72
v_mfma_f32_16x16x32_bf16 v[80:83], v[184:187], v[120:123], v[80:83]
ds_read_b64_tr_b16 a[216:217], v45 offset:0
v_mfma_f32_16x16x32_bf16 v[80:83], v[188:191], v[124:127], v[80:83]
v_exp_f32 v73, v73
v_mfma_f32_16x16x32_bf16 v[84:87], v[192:195], v[112:115], v[244:247]
ds_read_b64_tr_b16 a[218:219], v45 offset:4096
v_cvt_pk_bf16_f32 v72, v72, v73
v_mfma_f32_16x16x32_bf16 v[84:87], v[196:199], v[116:119], v[84:87]
v_exp_f32 v74, v74
v_mfma_f32_16x16x32_bf16 v[84:87], v[200:203], v[120:123], v[84:87]
ds_read_b64_tr_b16 a[220:221], v46 offset:0
s_add_u32 m0, s61, 16384
v_mfma_f32_16x16x32_bf16 v[84:87], v[204:207], v[124:127], v[84:87]
v_exp_f32 v75, v75
v_mfma_f32_16x16x32_bf16 a[128:131], a[224:227], v[64:67], a[128:131]
v_exp_f32 v76, v76
v_mfma_f32_16x16x32_bf16 a[132:135], a[228:231], v[64:67], a[132:135]
ds_read_b64_tr_b16 a[222:223], v46 offset:4096
buffer_load_dwordx4 v19, s[8:11], s57 offen offset:0 lds
v_cvt_pk_bf16_f32 v73, v74, v75
v_mfma_f32_16x16x32_bf16 a[136:139], a[232:235], v[64:67], a[136:139]
v_exp_f32 v77, v77
v_mfma_f32_16x16x32_bf16 a[140:143], a[236:239], v[64:67], a[140:143]
v_cvt_pk_bf16_f32 v74, v76, v77
v_mfma_f32_16x16x32_bf16 a[144:147], a[240:243], v[64:67], a[144:147]
v_exp_f32 v78, v78
v_mfma_f32_16x16x32_bf16 a[148:151], a[244:247], v[64:67], a[148:151]
v_mfma_f32_16x16x32_bf16 a[152:155], a[248:251], v[64:67], a[152:155]
v_exp_f32 v79, v79
v_mfma_f32_16x16x32_bf16 a[156:159], a[252:255], v[64:67], a[156:159]
v_cvt_pk_bf16_f32 v75, v78, v79
v_mfma_f32_16x16x32_bf16 a[176:179], v[88:91], v[64:67], a[176:179]
s_waitcnt lgkmcnt(0)
buffer_load_dwordx4 v20, s[8:11], s57 offen offset:1024 lds
v_mfma_f32_16x16x32_bf16 v[56:59], v[176:179], v[128:131], v[248:251]
v_mfma_f32_16x16x32_bf16 v[56:59], v[180:183], v[132:135], v[56:59]
v_exp_f32 v80, v80
v_mfma_f32_16x16x32_bf16 v[56:59], v[184:187], v[136:139], v[56:59]
v_mfma_f32_16x16x32_bf16 v[56:59], v[188:191], v[140:143], v[56:59]
v_exp_f32 v81, v81
v_mfma_f32_16x16x32_bf16 v[60:63], v[192:195], v[128:131], v[248:251]
v_cvt_pk_bf16_f32 v80, v80, v81
v_mfma_f32_16x16x32_bf16 v[60:63], v[196:199], v[132:135], v[60:63]
v_exp_f32 v82, v82
v_mfma_f32_16x16x32_bf16 v[60:63], v[200:203], v[136:139], v[60:63]
v_mfma_f32_16x16x32_bf16 v[60:63], v[204:207], v[140:143], v[60:63]
v_exp_f32 v83, v83
v_mfma_f32_16x16x32_bf16 a[0:3], a[192:195], v[72:75], a[0:3]
v_exp_f32 v84, v84
v_mfma_f32_16x16x32_bf16 a[4:7], a[196:199], v[72:75], a[4:7]
v_cvt_pk_bf16_f32 v81, v82, v83
v_mfma_f32_16x16x32_bf16 a[8:11], a[200:203], v[72:75], a[8:11]
v_exp_f32 v85, v85
v_mfma_f32_16x16x32_bf16 a[12:15], a[204:207], v[72:75], a[12:15]
buffer_load_dwordx4 v21, s[8:11], s57 offen offset:2048 lds
v_cvt_pk_bf16_f32 v82, v84, v85
v_mfma_f32_16x16x32_bf16 a[16:19], a[208:211], v[72:75], a[16:19]
v_exp_f32 v86, v86
v_mfma_f32_16x16x32_bf16 a[20:23], a[212:215], v[72:75], a[20:23]
v_mfma_f32_16x16x32_bf16 a[24:27], a[216:219], v[72:75], a[24:27]
v_exp_f32 v87, v87
v_mfma_f32_16x16x32_bf16 a[28:31], a[220:223], v[72:75], a[28:31]
v_cvt_pk_bf16_f32 v83, v86, v87
v_mfma_f32_16x16x32_bf16 a[160:163], v[88:91], v[72:75], a[160:163]
s_waitcnt vmcnt(7) lgkmcnt(0)
s_barrier
v_mfma_f32_16x16x32_bf16 v[64:67], v[176:179], v[144:147], v[252:255]
v_mfma_f32_16x16x32_bf16 v[64:67], v[180:183], v[148:151], v[64:67]
v_exp_f32 v56, v56
v_mfma_f32_16x16x32_bf16 v[64:67], v[184:187], v[152:155], v[64:67]
v_mfma_f32_16x16x32_bf16 v[64:67], v[188:191], v[156:159], v[64:67]
v_exp_f32 v57, v57
v_mfma_f32_16x16x32_bf16 v[68:71], v[192:195], v[144:147], v[252:255]
buffer_load_dwordx4 v22, s[8:11], s57 offen offset:3072 lds
v_cvt_pk_bf16_f32 v56, v56, v57
v_mfma_f32_16x16x32_bf16 v[68:71], v[196:199], v[148:151], v[68:71]
v_exp_f32 v58, v58
v_mfma_f32_16x16x32_bf16 v[68:71], v[200:203], v[152:155], v[68:71]
ds_read_b128 v[208:211], v27 offset:32768
ds_read_b128 v[212:215], v28 offset:32768
v_mfma_f32_16x16x32_bf16 v[68:71], v[204:207], v[156:159], v[68:71]
v_exp_f32 v59, v59
v_mfma_f32_16x16x32_bf16 a[32:35], a[192:195], v[80:83], a[32:35]
v_exp_f32 v60, v60
v_mfma_f32_16x16x32_bf16 a[36:39], a[196:199], v[80:83], a[36:39]
ds_read_b128 v[216:219], v29 offset:32768
v_cvt_pk_bf16_f32 v57, v58, v59
v_mfma_f32_16x16x32_bf16 a[40:43], a[200:203], v[80:83], a[40:43]
v_exp_f32 v61, v61
v_mfma_f32_16x16x32_bf16 a[44:47], a[204:207], v[80:83], a[44:47]
ds_read_b128 v[220:223], v30 offset:32768
v_cvt_pk_bf16_f32 v58, v60, v61
v_mfma_f32_16x16x32_bf16 a[48:51], a[208:211], v[80:83], a[48:51]
v_exp_f32 v62, v62
v_mfma_f32_16x16x32_bf16 a[52:55], a[212:215], v[80:83], a[52:55]
v_mfma_f32_16x16x32_bf16 a[56:59], a[216:219], v[80:83], a[56:59]
v_exp_f32 v63, v63
v_mfma_f32_16x16x32_bf16 a[60:63], a[220:223], v[80:83], a[60:63]
s_add_u32 m0, s61, 32768
v_cvt_pk_bf16_f32 v59, v62, v63
v_mfma_f32_16x16x32_bf16 a[164:167], v[88:91], v[80:83], a[164:167]
buffer_load_dwordx4 v19, s[8:11], s58 offen offset:0 lds
ds_read_b128 v[224:227], v27 offset:36864
v_mfma_f32_16x16x32_bf16 v[72:75], v[176:179], v[160:163], v[92:95]
ds_read_b128 v[228:231], v28 offset:36864
v_mfma_f32_16x16x32_bf16 v[72:75], v[180:183], v[164:167], v[72:75]
v_exp_f32 v64, v64
v_mfma_f32_16x16x32_bf16 v[72:75], v[184:187], v[168:171], v[72:75]
ds_read_b128 v[232:235], v29 offset:36864
v_mfma_f32_16x16x32_bf16 v[72:75], v[188:191], v[172:175], v[72:75]
v_exp_f32 v65, v65
v_mfma_f32_16x16x32_bf16 v[76:79], v[192:195], v[160:163], v[92:95]
v_cvt_pk_bf16_f32 v64, v64, v65
v_mfma_f32_16x16x32_bf16 v[76:79], v[196:199], v[164:167], v[76:79]
v_exp_f32 v66, v66
v_mfma_f32_16x16x32_bf16 v[76:79], v[200:203], v[168:171], v[76:79]
ds_read_b128 v[236:239], v30 offset:36864
v_mfma_f32_16x16x32_bf16 v[76:79], v[204:207], v[172:175], v[76:79]
v_exp_f32 v67, v67
v_mfma_f32_16x16x32_bf16 a[64:67], a[192:195], v[56:59], a[64:67]
v_exp_f32 v68, v68
v_mfma_f32_16x16x32_bf16 a[68:71], a[196:199], v[56:59], a[68:71]
buffer_load_dwordx4 v20, s[8:11], s58 offen offset:1024 lds
v_cvt_pk_bf16_f32 v65, v66, v67
v_mfma_f32_16x16x32_bf16 a[72:75], a[200:203], v[56:59], a[72:75]
v_exp_f32 v69, v69
v_mfma_f32_16x16x32_bf16 a[76:79], a[204:207], v[56:59], a[76:79]
v_cvt_pk_bf16_f32 v66, v68, v69
v_mfma_f32_16x16x32_bf16 a[80:83], a[208:211], v[56:59], a[80:83]
v_exp_f32 v70, v70
v_mfma_f32_16x16x32_bf16 a[84:87], a[212:215], v[56:59], a[84:87]
v_mfma_f32_16x16x32_bf16 a[88:91], a[216:219], v[56:59], a[88:91]
v_exp_f32 v71, v71
v_mfma_f32_16x16x32_bf16 a[92:95], a[220:223], v[56:59], a[92:95]
v_cvt_pk_bf16_f32 v67, v70, v71
v_mfma_f32_16x16x32_bf16 a[168:171], v[88:91], v[56:59], a[168:171]
s_waitcnt lgkmcnt(0)
v_mfma_f32_16x16x32_bf16 v[80:83], v[208:211], v[96:99], v[240:243]
ds_read_b64_tr_b16 a[224:225], v39 offset:32768
v_mfma_f32_16x16x32_bf16 v[80:83], v[212:215], v[100:103], v[80:83]
v_exp_f32 v72, v72
v_mfma_f32_16x16x32_bf16 v[80:83], v[216:219], v[104:107], v[80:83]
ds_read_b64_tr_b16 a[226:227], v39 offset:36864
buffer_load_dwordx4 v21, s[8:11], s58 offen offset:2048 lds
v_mfma_f32_16x16x32_bf16 v[80:83], v[220:223], v[108:111], v[80:83]
v_exp_f32 v73, v73
v_mfma_f32_16x16x32_bf16 v[84:87], v[224:227], v[96:99], v[240:243]
ds_read_b64_tr_b16 a[228:229], v40 offset:32768
v_cvt_pk_bf16_f32 v72, v72, v73
v_mfma_f32_16x16x32_bf16 v[84:87], v[228:231], v[100:103], v[84:87]
v_exp_f32 v74, v74
v_mfma_f32_16x16x32_bf16 v[84:87], v[232:235], v[104:107], v[84:87]
ds_read_b64_tr_b16 a[230:231], v40 offset:36864
ds_read_b64_tr_b16 a[232:233], v41 offset:32768
v_mfma_f32_16x16x32_bf16 v[84:87], v[236:239], v[108:111], v[84:87]
v_exp_f32 v75, v75
v_mfma_f32_16x16x32_bf16 a[96:99], a[192:195], v[64:67], a[96:99]
v_exp_f32 v76, v76
v_mfma_f32_16x16x32_bf16 a[100:103], a[196:199], v[64:67], a[100:103]
ds_read_b64_tr_b16 a[234:235], v41 offset:36864
v_cvt_pk_bf16_f32 v73, v74, v75
v_mfma_f32_16x16x32_bf16 a[104:107], a[200:203], v[64:67], a[104:107]
v_exp_f32 v77, v77
v_mfma_f32_16x16x32_bf16 a[108:111], a[204:207], v[64:67], a[108:111]
ds_read_b64_tr_b16 a[236:237], v42 offset:32768
v_cvt_pk_bf16_f32 v74, v76, v77
v_mfma_f32_16x16x32_bf16 a[112:115], a[208:211], v[64:67], a[112:115]
v_exp_f32 v78, v78
v_mfma_f32_16x16x32_bf16 a[116:119], a[212:215], v[64:67], a[116:119]
ds_read_b64_tr_b16 a[238:239], v42 offset:36864
ds_read_b64_tr_b16 a[240:241], v43 offset:32768
buffer_load_dwordx4 v22, s[8:11], s58 offen offset:3072 lds
v_mfma_f32_16x16x32_bf16 a[120:123], a[216:219], v[64:67], a[120:123]
v_exp_f32 v79, v79
v_mfma_f32_16x16x32_bf16 a[124:127], a[220:223], v[64:67], a[124:127]
ds_read_b64_tr_b16 a[242:243], v43 offset:36864
v_cvt_pk_bf16_f32 v75, v78, v79
v_mfma_f32_16x16x32_bf16 a[172:175], v[88:91], v[64:67], a[172:175]
ds_read_b64_tr_b16 a[244:245], v44 offset:32768
v_mfma_f32_16x16x32_bf16 v[56:59], v[208:211], v[112:115], v[244:247]
ds_read_b64_tr_b16 a[246:247], v44 offset:36864
v_mfma_f32_16x16x32_bf16 v[56:59], v[212:215], v[116:119], v[56:59]
v_exp_f32 v80, v80
v_mfma_f32_16x16x32_bf16 v[56:59], v[216:219], v[120:123], v[56:59]
ds_read_b64_tr_b16 a[248:249], v45 offset:32768
v_mfma_f32_16x16x32_bf16 v[56:59], v[220:223], v[124:127], v[56:59]
v_exp_f32 v81, v81
v_mfma_f32_16x16x32_bf16 v[60:63], v[224:227], v[112:115], v[244:247]
ds_read_b64_tr_b16 a[250:251], v45 offset:36864
v_cvt_pk_bf16_f32 v80, v80, v81
v_mfma_f32_16x16x32_bf16 v[60:63], v[228:231], v[116:119], v[60:63]
v_exp_f32 v82, v82
v_mfma_f32_16x16x32_bf16 v[60:63], v[232:235], v[120:123], v[60:63]
ds_read_b64_tr_b16 a[252:253], v46 offset:32768
s_add_u32 m0, s61, 49152
v_mfma_f32_16x16x32_bf16 v[60:63], v[236:239], v[124:127], v[60:63]
v_exp_f32 v83, v83
v_mfma_f32_16x16x32_bf16 a[128:131], a[192:195], v[72:75], a[128:131]
v_exp_f32 v84, v84
v_mfma_f32_16x16x32_bf16 a[132:135], a[196:199], v[72:75], a[132:135]
ds_read_b64_tr_b16 a[254:255], v46 offset:36864
buffer_load_dwordx4 v19, s[8:11], s59 offen offset:0 lds
v_cvt_pk_bf16_f32 v81, v82, v83
v_mfma_f32_16x16x32_bf16 a[136:139], a[200:203], v[72:75], a[136:139]
v_exp_f32 v85, v85
v_mfma_f32_16x16x32_bf16 a[140:143], a[204:207], v[72:75], a[140:143]
v_cvt_pk_bf16_f32 v82, v84, v85
v_mfma_f32_16x16x32_bf16 a[144:147], a[208:211], v[72:75], a[144:147]
v_exp_f32 v86, v86
v_mfma_f32_16x16x32_bf16 a[148:151], a[212:215], v[72:75], a[148:151]
v_mfma_f32_16x16x32_bf16 a[152:155], a[216:219], v[72:75], a[152:155]
v_exp_f32 v87, v87
v_mfma_f32_16x16x32_bf16 a[156:159], a[220:223], v[72:75], a[156:159]
v_cvt_pk_bf16_f32 v83, v86, v87
v_mfma_f32_16x16x32_bf16 a[176:179], v[88:91], v[72:75], a[176:179]
s_waitcnt lgkmcnt(0)
buffer_load_dwordx4 v20, s[8:11], s59 offen offset:1024 lds
v_mfma_f32_16x16x32_bf16 v[64:67], v[208:211], v[128:131], v[248:251]
v_mfma_f32_16x16x32_bf16 v[64:67], v[212:215], v[132:135], v[64:67]
v_exp_f32 v56, v56
v_mfma_f32_16x16x32_bf16 v[64:67], v[216:219], v[136:139], v[64:67]
v_mfma_f32_16x16x32_bf16 v[64:67], v[220:223], v[140:143], v[64:67]
v_exp_f32 v57, v57
v_mfma_f32_16x16x32_bf16 v[68:71], v[224:227], v[128:131], v[248:251]
v_cvt_pk_bf16_f32 v56, v56, v57
v_mfma_f32_16x16x32_bf16 v[68:71], v[228:231], v[132:135], v[68:71]
v_exp_f32 v58, v58
v_mfma_f32_16x16x32_bf16 v[68:71], v[232:235], v[136:139], v[68:71]
v_mfma_f32_16x16x32_bf16 v[68:71], v[236:239], v[140:143], v[68:71]
v_exp_f32 v59, v59
v_mfma_f32_16x16x32_bf16 a[0:3], a[224:227], v[80:83], a[0:3]
v_exp_f32 v60, v60
v_mfma_f32_16x16x32_bf16 a[4:7], a[228:231], v[80:83], a[4:7]
v_cvt_pk_bf16_f32 v57, v58, v59
v_mfma_f32_16x16x32_bf16 a[8:11], a[232:235], v[80:83], a[8:11]
v_exp_f32 v61, v61
v_mfma_f32_16x16x32_bf16 a[12:15], a[236:239], v[80:83], a[12:15]
buffer_load_dwordx4 v21, s[8:11], s59 offen offset:2048 lds
v_cvt_pk_bf16_f32 v58, v60, v61
v_mfma_f32_16x16x32_bf16 a[16:19], a[240:243], v[80:83], a[16:19]
v_exp_f32 v62, v62
v_mfma_f32_16x16x32_bf16 a[20:23], a[244:247], v[80:83], a[20:23]
v_mfma_f32_16x16x32_bf16 a[24:27], a[248:251], v[80:83], a[24:27]
v_exp_f32 v63, v63
v_mfma_f32_16x16x32_bf16 a[28:31], a[252:255], v[80:83], a[28:31]
v_cvt_pk_bf16_f32 v59, v62, v63
v_mfma_f32_16x16x32_bf16 a[160:163], v[88:91], v[80:83], a[160:163]
s_waitcnt vmcnt(63) lgkmcnt(0)
s_barrier
s_nop 1
v_accvgpr_read_b32 v192, a0
v_accvgpr_read_b32 v193, a1
v_accvgpr_read_b32 v194, a2
v_accvgpr_read_b32 v195, a3
v_accvgpr_read_b32 v196, a4
v_accvgpr_read_b32 v197, a5
v_accvgpr_read_b32 v198, a6
v_accvgpr_read_b32 v199, a7
v_accvgpr_read_b32 v1, a160
v_accvgpr_read_b32 v12, a160
s_nop 1
v_permlane16_swap_b32 v1, v12
v_mov_b32 v12, v1
s_nop 1
v_permlane32_swap_b32 v1, v12
v_rcp_f32 v12, v1
v_cmp_le_f32 vcc, s30, v1
s_and_b64 s[44:45], s[44:45], vcc
v_cmp_ge_f32 vcc, s31, v1
s_and_b64 s[44:45], s[44:45], vcc
v_pk_mul_f32 v[192:193], v[192:193], v[12:13] op_sel_hi:[1,0]
v_pk_mul_f32 v[194:195], v[194:195], v[12:13] op_sel_hi:[1,0]
v_pk_mul_f32 v[196:197], v[196:197], v[12:13] op_sel_hi:[1,0]
v_pk_mul_f32 v[198:199], v[198:199], v[12:13] op_sel_hi:[1,0]
v_cvt_pk_bf16_f32 v176, v192, v193
v_cvt_pk_bf16_f32 v177, v194, v195
v_cvt_pk_bf16_f32 v178, v196, v197
v_cvt_pk_bf16_f32 v179, v198, v199
v_accvgpr_read_b32 v200, a8
v_accvgpr_read_b32 v201, a9
v_accvgpr_read_b32 v202, a10
v_accvgpr_read_b32 v203, a11
v_accvgpr_read_b32 v204, a12
v_accvgpr_read_b32 v205, a13
v_accvgpr_read_b32 v206, a14
v_accvgpr_read_b32 v207, a15
v_pk_mul_f32 v[200:201], v[200:201], v[12:13] op_sel_hi:[1,0]
v_pk_mul_f32 v[202:203], v[202:203], v[12:13] op_sel_hi:[1,0]
v_pk_mul_f32 v[204:205], v[204:205], v[12:13] op_sel_hi:[1,0]
v_pk_mul_f32 v[206:207], v[206:207], v[12:13] op_sel_hi:[1,0]
v_cvt_pk_bf16_f32 v180, v200, v201
v_cvt_pk_bf16_f32 v181, v202, v203
v_cvt_pk_bf16_f32 v182, v204, v205
v_cvt_pk_bf16_f32 v183, v206, v207
buffer_store_dwordx4 v[176:179], v51, s[16:19], s42 offen offset:0 sc1
ds_write_b128 v2, v[176:179] offset:0
buffer_store_dwordx4 v[180:183], v51, s[16:19], s42 offen offset:1024 sc1
ds_write_b128 v2, v[180:183] offset:1024
v_accvgpr_read_b32 v192, a16
v_accvgpr_read_b32 v193, a17
v_accvgpr_read_b32 v194, a18
v_accvgpr_read_b32 v195, a19
v_accvgpr_read_b32 v196, a20
v_accvgpr_read_b32 v197, a21
v_accvgpr_read_b32 v198, a22
v_accvgpr_read_b32 v199, a23
v_pk_mul_f32 v[192:193], v[192:193], v[12:13] op_sel_hi:[1,0]
v_pk_mul_f32 v[194:195], v[194:195], v[12:13] op_sel_hi:[1,0]
v_pk_mul_f32 v[196:197], v[196:197], v[12:13] op_sel_hi:[1,0]
v_pk_mul_f32 v[198:199], v[198:199], v[12:13] op_sel_hi:[1,0]
v_cvt_pk_bf16_f32 v184, v192, v193
v_cvt_pk_bf16_f32 v185, v194, v195
v_cvt_pk_bf16_f32 v186, v196, v197
v_cvt_pk_bf16_f32 v187, v198, v199
v_accvgpr_read_b32 v200, a24
v_accvgpr_read_b32 v201, a25
v_accvgpr_read_b32 v202, a26
v_accvgpr_read_b32 v203, a27
v_accvgpr_read_b32 v204, a28
v_accvgpr_read_b32 v205, a29
v_accvgpr_read_b32 v206, a30
v_accvgpr_read_b32 v207, a31
v_pk_mul_f32 v[200:201], v[200:201], v[12:13] op_sel_hi:[1,0]
v_pk_mul_f32 v[202:203], v[202:203], v[12:13] op_sel_hi:[1,0]
v_pk_mul_f32 v[204:205], v[204:205], v[12:13] op_sel_hi:[1,0]
v_pk_mul_f32 v[206:207], v[206:207], v[12:13] op_sel_hi:[1,0]
v_cvt_pk_bf16_f32 v188, v200, v201
v_cvt_pk_bf16_f32 v189, v202, v203
v_cvt_pk_bf16_f32 v190, v204, v205
v_cvt_pk_bf16_f32 v191, v206, v207
buffer_store_dwordx4 v[184:187], v51, s[16:19], s43 offen offset:0 sc1
ds_write_b128 v3, v[184:187] offset:0
buffer_store_dwordx4 v[188:191], v51, s[16:19], s43 offen offset:1024 sc1
ds_write_b128 v3, v[188:191] offset:1024
v_mfma_f32_16x16x32_bf16 v[72:75], v[208:211], v[144:147], v[252:255]
v_mfma_f32_16x16x32_bf16 v[72:75], v[212:215], v[148:151], v[72:75]
v_exp_f32 v64, v64
v_mfma_f32_16x16x32_bf16 v[72:75], v[216:219], v[152:155], v[72:75]
v_mfma_f32_16x16x32_bf16 v[72:75], v[220:223], v[156:159], v[72:75]
v_exp_f32 v65, v65
v_mfma_f32_16x16x32_bf16 v[76:79], v[224:227], v[144:147], v[252:255]
buffer_load_dwordx4 v22, s[8:11], s59 offen offset:3072 lds
v_cvt_pk_bf16_f32 v64, v64, v65
v_mfma_f32_16x16x32_bf16 v[76:79], v[228:231], v[148:151], v[76:79]
v_exp_f32 v66, v66
v_mfma_f32_16x16x32_bf16 v[76:79], v[232:235], v[152:155], v[76:79]
v_mfma_f32_16x16x32_bf16 v[76:79], v[236:239], v[156:159], v[76:79]
v_exp_f32 v67, v67
v_mfma_f32_16x16x32_bf16 a[32:35], a[224:227], v[56:59], a[32:35]
v_exp_f32 v68, v68
v_mfma_f32_16x16x32_bf16 a[36:39], a[228:231], v[56:59], a[36:39]
v_cvt_pk_bf16_f32 v65, v66, v67
v_mfma_f32_16x16x32_bf16 a[40:43], a[232:235], v[56:59], a[40:43]
v_exp_f32 v69, v69
v_mfma_f32_16x16x32_bf16 a[44:47], a[236:239], v[56:59], a[44:47]
v_cvt_pk_bf16_f32 v66, v68, v69
v_mfma_f32_16x16x32_bf16 a[48:51], a[240:243], v[56:59], a[48:51]
v_exp_f32 v70, v70
v_mfma_f32_16x16x32_bf16 a[52:55], a[244:247], v[56:59], a[52:55]
v_mfma_f32_16x16x32_bf16 a[56:59], a[248:251], v[56:59], a[56:59]
v_exp_f32 v71, v71
v_mfma_f32_16x16x32_bf16 a[60:63], a[252:255], v[56:59], a[60:63]
v_cvt_pk_bf16_f32 v67, v70, v71
v_mfma_f32_16x16x32_bf16 a[164:167], v[88:91], v[56:59], a[164:167]
v_mfma_f32_16x16x32_bf16 v[80:83], v[208:211], v[160:163], v[92:95]
v_mfma_f32_16x16x32_bf16 v[80:83], v[212:215], v[164:167], v[80:83]
v_exp_f32 v72, v72
v_mfma_f32_16x16x32_bf16 v[80:83], v[216:219], v[168:171], v[80:83]
v_mfma_f32_16x16x32_bf16 v[80:83], v[220:223], v[172:175], v[80:83]
v_exp_f32 v73, v73
v_mfma_f32_16x16x32_bf16 v[84:87], v[224:227], v[160:163], v[92:95]
v_cvt_pk_bf16_f32 v72, v72, v73
v_mfma_f32_16x16x32_bf16 v[84:87], v[228:231], v[164:167], v[84:87]
v_exp_f32 v74, v74
v_mfma_f32_16x16x32_bf16 v[84:87], v[232:235], v[168:171], v[84:87]
v_mfma_f32_16x16x32_bf16 v[84:87], v[236:239], v[172:175], v[84:87]
v_exp_f32 v75, v75
v_mfma_f32_16x16x32_bf16 a[64:67], a[224:227], v[64:67], a[64:67]
v_exp_f32 v76, v76
v_mfma_f32_16x16x32_bf16 a[68:71], a[228:231], v[64:67], a[68:71]
v_cvt_pk_bf16_f32 v73, v74, v75
v_mfma_f32_16x16x32_bf16 a[72:75], a[232:235], v[64:67], a[72:75]
v_exp_f32 v77, v77
v_mfma_f32_16x16x32_bf16 a[76:79], a[236:239], v[64:67], a[76:79]
v_cvt_pk_bf16_f32 v74, v76, v77
v_mfma_f32_16x16x32_bf16 a[80:83], a[240:243], v[64:67], a[80:83]
v_exp_f32 v78, v78
v_mfma_f32_16x16x32_bf16 a[84:87], a[244:247], v[64:67], a[84:87]
v_mfma_f32_16x16x32_bf16 a[88:91], a[248:251], v[64:67], a[88:91]
v_exp_f32 v79, v79
v_mfma_f32_16x16x32_bf16 a[92:95], a[252:255], v[64:67], a[92:95]
v_cvt_pk_bf16_f32 v75, v78, v79
v_mfma_f32_16x16x32_bf16 a[168:171], v[88:91], v[64:67], a[168:171]
buffer_load_dword v13, off, s[16:19], s50 sc1
v_mfma_f32_16x16x32_bf16 a[96:99], a[224:227], v[72:75], a[96:99]
v_exp_f32 v80, v80
v_mfma_f32_16x16x32_bf16 a[100:103], a[228:231], v[72:75], a[100:103]
v_exp_f32 v81, v81
v_mfma_f32_16x16x32_bf16 a[104:107], a[232:235], v[72:75], a[104:107]
v_exp_f32 v82, v82
v_mfma_f32_16x16x32_bf16 a[108:111], a[236:239], v[72:75], a[108:111]
v_exp_f32 v83, v83
v_mfma_f32_16x16x32_bf16 a[112:115], a[240:243], v[72:75], a[112:115]
v_exp_f32 v84, v84
v_mfma_f32_16x16x32_bf16 a[116:119], a[244:247], v[72:75], a[116:119]
v_exp_f32 v85, v85
v_mfma_f32_16x16x32_bf16 a[120:123], a[248:251], v[72:75], a[120:123]
v_exp_f32 v86, v86
v_mfma_f32_16x16x32_bf16 a[124:127], a[252:255], v[72:75], a[124:127]
v_exp_f32 v87, v87
v_mfma_f32_16x16x32_bf16 a[172:175], v[88:91], v[72:75], a[172:175]
v_cvt_pk_bf16_f32 v80, v80, v81
v_cvt_pk_bf16_f32 v81, v82, v83
v_cvt_pk_bf16_f32 v82, v84, v85
v_cvt_pk_bf16_f32 v83, v86, v87
v_add_u32 v95, 4096, v51
v_add_u32 v94, 8192, v51
v_mfma_f32_16x16x32_bf16 a[128:131], a[224:227], v[80:83], a[128:131]
v_mfma_f32_16x16x32_bf16 a[132:135], a[228:231], v[80:83], a[132:135]
v_mfma_f32_16x16x32_bf16 a[136:139], a[232:235], v[80:83], a[136:139]
v_mfma_f32_16x16x32_bf16 a[140:143], a[236:239], v[80:83], a[140:143]
v_mfma_f32_16x16x32_bf16 a[144:147], a[240:243], v[80:83], a[144:147]
v_mfma_f32_16x16x32_bf16 a[148:151], a[244:247], v[80:83], a[148:151]
v_mfma_f32_16x16x32_bf16 a[152:155], a[248:251], v[80:83], a[152:155]
v_mfma_f32_16x16x32_bf16 a[156:159], a[252:255], v[80:83], a[156:159]
v_mfma_f32_16x16x32_bf16 a[176:179], v[88:91], v[80:83], a[176:179]
v_accvgpr_read_b32 v56, a32
v_accvgpr_read_b32 v57, a33
v_accvgpr_read_b32 v58, a34
v_accvgpr_read_b32 v59, a35
v_accvgpr_read_b32 v60, a36
v_accvgpr_read_b32 v61, a37
v_accvgpr_read_b32 v62, a38
v_accvgpr_read_b32 v63, a39
v_accvgpr_read_b32 v1, a164
v_accvgpr_read_b32 v12, a164
s_nop 1
v_permlane16_swap_b32 v1, v12
v_mov_b32 v12, v1
s_nop 1
v_permlane32_swap_b32 v1, v12
v_rcp_f32 v12, v1
v_cmp_le_f32 vcc, s30, v1
s_and_b64 s[44:45], s[44:45], vcc
v_cmp_ge_f32 vcc, s31, v1
s_and_b64 s[44:45], s[44:45], vcc
v_pk_mul_f32 v[56:57], v[56:57], v[12:13] op_sel_hi:[1,0]
v_pk_mul_f32 v[58:59], v[58:59], v[12:13] op_sel_hi:[1,0]
v_pk_mul_f32 v[60:61], v[60:61], v[12:13] op_sel_hi:[1,0]
v_pk_mul_f32 v[62:63], v[62:63], v[12:13] op_sel_hi:[1,0]
v_cvt_pk_bf16_f32 v192, v56, v57
v_cvt_pk_bf16_f32 v193, v58, v59
v_cvt_pk_bf16_f32 v194, v60, v61
v_cvt_pk_bf16_f32 v195, v62, v63
v_accvgpr_read_b32 v64, a40
v_accvgpr_read_b32 v65, a41
v_accvgpr_read_b32 v66, a42
v_accvgpr_read_b32 v67, a43
v_accvgpr_read_b32 v68, a44
v_accvgpr_read_b32 v69, a45
v_accvgpr_read_b32 v70, a46
v_accvgpr_read_b32 v71, a47
v_pk_mul_f32 v[64:65], v[64:65], v[12:13] op_sel_hi:[1,0]
v_pk_mul_f32 v[66:67], v[66:67], v[12:13] op_sel_hi:[1,0]
v_pk_mul_f32 v[68:69], v[68:69], v[12:13] op_sel_hi:[1,0]
v_pk_mul_f32 v[70:71], v[70:71], v[12:13] op_sel_hi:[1,0]
v_cvt_pk_bf16_f32 v196, v64, v65
v_cvt_pk_bf16_f32 v197, v66, v67
v_cvt_pk_bf16_f32 v198, v68, v69
v_cvt_pk_bf16_f32 v199, v70, v71
buffer_store_dwordx4 v[192:195], v51, s[16:19], s42 offen offset:2048 sc1
ds_write_b128 v2, v[192:195] offset:2048
buffer_store_dwordx4 v[196:199], v51, s[16:19], s42 offen offset:3072 sc1
ds_write_b128 v2, v[196:199] offset:3072
v_accvgpr_read_b32 v56, a48
v_accvgpr_read_b32 v57, a49
v_accvgpr_read_b32 v58, a50
v_accvgpr_read_b32 v59, a51
v_accvgpr_read_b32 v60, a52
v_accvgpr_read_b32 v61, a53
v_accvgpr_read_b32 v62, a54
v_accvgpr_read_b32 v63, a55
v_pk_mul_f32 v[56:57], v[56:57], v[12:13] op_sel_hi:[1,0]
v_pk_mul_f32 v[58:59], v[58:59], v[12:13] op_sel_hi:[1,0]
v_pk_mul_f32 v[60:61], v[60:61], v[12:13] op_sel_hi:[1,0]
v_pk_mul_f32 v[62:63], v[62:63], v[12:13] op_sel_hi:[1,0]
v_cvt_pk_bf16_f32 v200, v56, v57
v_cvt_pk_bf16_f32 v201, v58, v59
v_cvt_pk_bf16_f32 v202, v60, v61
v_cvt_pk_bf16_f32 v203, v62, v63
v_accvgpr_read_b32 v64, a56
v_accvgpr_read_b32 v65, a57
v_accvgpr_read_b32 v66, a58
v_accvgpr_read_b32 v67, a59
v_accvgpr_read_b32 v68, a60
v_accvgpr_read_b32 v69, a61
v_accvgpr_read_b32 v70, a62
v_accvgpr_read_b32 v71, a63
v_pk_mul_f32 v[64:65], v[64:65], v[12:13] op_sel_hi:[1,0]
v_pk_mul_f32 v[66:67], v[66:67], v[12:13] op_sel_hi:[1,0]
v_pk_mul_f32 v[68:69], v[68:69], v[12:13] op_sel_hi:[1,0]
v_pk_mul_f32 v[70:71], v[70:71], v[12:13] op_sel_hi:[1,0]
v_cvt_pk_bf16_f32 v204, v64, v65
v_cvt_pk_bf16_f32 v205, v66, v67
v_cvt_pk_bf16_f32 v206, v68, v69
v_cvt_pk_bf16_f32 v207, v70, v71
buffer_store_dwordx4 v[200:203], v51, s[16:19], s43 offen offset:2048 sc1
ds_write_b128 v3, v[200:203] offset:2048
buffer_store_dwordx4 v[204:207], v51, s[16:19], s43 offen offset:3072 sc1
ds_write_b128 v3, v[204:207] offset:3072
v_accvgpr_read_b32 v56, a64
v_accvgpr_read_b32 v57, a65
v_accvgpr_read_b32 v58, a66
v_accvgpr_read_b32 v59, a67
v_accvgpr_read_b32 v60, a68
v_accvgpr_read_b32 v61, a69
v_accvgpr_read_b32 v62, a70
v_accvgpr_read_b32 v63, a71
v_accvgpr_read_b32 v1, a168
v_accvgpr_read_b32 v12, a168
s_nop 1
v_permlane16_swap_b32 v1, v12
v_mov_b32 v12, v1
s_nop 1
v_permlane32_swap_b32 v1, v12
v_rcp_f32 v12, v1
v_cmp_le_f32 vcc, s30, v1
s_and_b64 s[44:45], s[44:45], vcc
v_cmp_ge_f32 vcc, s31, v1
s_and_b64 s[44:45], s[44:45], vcc
v_pk_mul_f32 v[56:57], v[56:57], v[12:13] op_sel_hi:[1,0]
v_pk_mul_f32 v[58:59], v[58:59], v[12:13] op_sel_hi:[1,0]
v_pk_mul_f32 v[60:61], v[60:61], v[12:13] op_sel_hi:[1,0]
v_pk_mul_f32 v[62:63], v[62:63], v[12:13] op_sel_hi:[1,0]
v_cvt_pk_bf16_f32 v208, v56, v57
v_cvt_pk_bf16_f32 v209, v58, v59
v_cvt_pk_bf16_f32 v210, v60, v61
v_cvt_pk_bf16_f32 v211, v62, v63
v_accvgpr_read_b32 v64, a72
v_accvgpr_read_b32 v65, a73
v_accvgpr_read_b32 v66, a74
v_accvgpr_read_b32 v67, a75
v_accvgpr_read_b32 v68, a76
v_accvgpr_read_b32 v69, a77
v_accvgpr_read_b32 v70, a78
v_accvgpr_read_b32 v71, a79
v_pk_mul_f32 v[64:65], v[64:65], v[12:13] op_sel_hi:[1,0]
v_pk_mul_f32 v[66:67], v[66:67], v[12:13] op_sel_hi:[1,0]
v_pk_mul_f32 v[68:69], v[68:69], v[12:13] op_sel_hi:[1,0]
v_pk_mul_f32 v[70:71], v[70:71], v[12:13] op_sel_hi:[1,0]
v_cvt_pk_bf16_f32 v212, v64, v65
v_cvt_pk_bf16_f32 v213, v66, v67
v_cvt_pk_bf16_f32 v214, v68, v69
v_cvt_pk_bf16_f32 v215, v70, v71
buffer_store_dwordx4 v[208:211], v95, s[16:19], s42 offen offset:0 sc1
ds_write_b128 v2, v[208:211] offset:4096
buffer_store_dwordx4 v[212:215], v95, s[16:19], s42 offen offset:1024 sc1
ds_write_b128 v2, v[212:215] offset:5120
v_accvgpr_read_b32 v56, a80
v_accvgpr_read_b32 v57, a81
v_accvgpr_read_b32 v58, a82
v_accvgpr_read_b32 v59, a83
v_accvgpr_read_b32 v60, a84
v_accvgpr_read_b32 v61, a85
v_accvgpr_read_b32 v62, a86
v_accvgpr_read_b32 v63, a87
v_pk_mul_f32 v[56:57], v[56:57], v[12:13] op_sel_hi:[1,0]
v_pk_mul_f32 v[58:59], v[58:59], v[12:13] op_sel_hi:[1,0]
v_pk_mul_f32 v[60:61], v[60:61], v[12:13] op_sel_hi:[1,0]
v_pk_mul_f32 v[62:63], v[62:63], v[12:13] op_sel_hi:[1,0]
v_cvt_pk_bf16_f32 v216, v56, v57
v_cvt_pk_bf16_f32 v217, v58, v59
v_cvt_pk_bf16_f32 v218, v60, v61
v_cvt_pk_bf16_f32 v219, v62, v63
v_accvgpr_read_b32 v64, a88
v_accvgpr_read_b32 v65, a89
v_accvgpr_read_b32 v66, a90
v_accvgpr_read_b32 v67, a91
v_accvgpr_read_b32 v68, a92
v_accvgpr_read_b32 v69, a93
v_accvgpr_read_b32 v70, a94
v_accvgpr_read_b32 v71, a95
v_pk_mul_f32 v[64:65], v[64:65], v[12:13] op_sel_hi:[1,0]
v_pk_mul_f32 v[66:67], v[66:67], v[12:13] op_sel_hi:[1,0]
v_pk_mul_f32 v[68:69], v[68:69], v[12:13] op_sel_hi:[1,0]
v_pk_mul_f32 v[70:71], v[70:71], v[12:13] op_sel_hi:[1,0]
v_cvt_pk_bf16_f32 v220, v64, v65
v_cvt_pk_bf16_f32 v221, v66, v67
v_cvt_pk_bf16_f32 v222, v68, v69
v_cvt_pk_bf16_f32 v223, v70, v71
buffer_store_dwordx4 v[216:219], v95, s[16:19], s43 offen offset:0 sc1
ds_write_b128 v3, v[216:219] offset:4096
buffer_store_dwordx4 v[220:223], v95, s[16:19], s43 offen offset:1024 sc1
ds_write_b128 v3, v[220:223] offset:5120
v_accvgpr_read_b32 v56, a96
v_accvgpr_read_b32 v57, a97
v_accvgpr_read_b32 v58, a98
v_accvgpr_read_b32 v59, a99
v_accvgpr_read_b32 v60, a100
v_accvgpr_read_b32 v61, a101
v_accvgpr_read_b32 v62, a102
v_accvgpr_read_b32 v63, a103
v_accvgpr_read_b32 v1, a172
v_accvgpr_read_b32 v12, a172
s_nop 1
v_permlane16_swap_b32 v1, v12
v_mov_b32 v12, v1
s_nop 1
v_permlane32_swap_b32 v1, v12
v_rcp_f32 v12, v1
v_cmp_le_f32 vcc, s30, v1
s_and_b64 s[44:45], s[44:45], vcc
v_cmp_ge_f32 vcc, s31, v1
s_and_b64 s[44:45], s[44:45], vcc
v_pk_mul_f32 v[56:57], v[56:57], v[12:13] op_sel_hi:[1,0]
v_pk_mul_f32 v[58:59], v[58:59], v[12:13] op_sel_hi:[1,0]
v_pk_mul_f32 v[60:61], v[60:61], v[12:13] op_sel_hi:[1,0]
v_pk_mul_f32 v[62:63], v[62:63], v[12:13] op_sel_hi:[1,0]
v_cvt_pk_bf16_f32 v224, v56, v57
v_cvt_pk_bf16_f32 v225, v58, v59
v_cvt_pk_bf16_f32 v226, v60, v61
v_cvt_pk_bf16_f32 v227, v62, v63
v_accvgpr_read_b32 v64, a104
v_accvgpr_read_b32 v65, a105
v_accvgpr_read_b32 v66, a106
v_accvgpr_read_b32 v67, a107
v_accvgpr_read_b32 v68, a108
v_accvgpr_read_b32 v69, a109
v_accvgpr_read_b32 v70, a110
v_accvgpr_read_b32 v71, a111
v_pk_mul_f32 v[64:65], v[64:65], v[12:13] op_sel_hi:[1,0]
v_pk_mul_f32 v[66:67], v[66:67], v[12:13] op_sel_hi:[1,0]
v_pk_mul_f32 v[68:69], v[68:69], v[12:13] op_sel_hi:[1,0]
v_pk_mul_f32 v[70:71], v[70:71], v[12:13] op_sel_hi:[1,0]
v_cvt_pk_bf16_f32 v228, v64, v65
v_cvt_pk_bf16_f32 v229, v66, v67
v_cvt_pk_bf16_f32 v230, v68, v69
v_cvt_pk_bf16_f32 v231, v70, v71
buffer_store_dwordx4 v[224:227], v95, s[16:19], s42 offen offset:2048 sc1
ds_write_b128 v2, v[224:227] offset:6144
buffer_store_dwordx4 v[228:231], v95, s[16:19], s42 offen offset:3072 sc1
ds_write_b128 v2, v[228:231] offset:7168
v_accvgpr_read_b32 v56, a112
v_accvgpr_read_b32 v57, a113
v_accvgpr_read_b32 v58, a114
v_accvgpr_read_b32 v59, a115
v_accvgpr_read_b32 v60, a116
v_accvgpr_read_b32 v61, a117
v_accvgpr_read_b32 v62, a118
v_accvgpr_read_b32 v63, a119
v_pk_mul_f32 v[56:57], v[56:57], v[12:13] op_sel_hi:[1,0]
v_pk_mul_f32 v[58:59], v[58:59], v[12:13] op_sel_hi:[1,0]
v_pk_mul_f32 v[60:61], v[60:61], v[12:13] op_sel_hi:[1,0]
v_pk_mul_f32 v[62:63], v[62:63], v[12:13] op_sel_hi:[1,0]
v_cvt_pk_bf16_f32 v232, v56, v57
v_cvt_pk_bf16_f32 v233, v58, v59
v_cvt_pk_bf16_f32 v234, v60, v61
v_cvt_pk_bf16_f32 v235, v62, v63
v_accvgpr_read_b32 v64, a120
v_accvgpr_read_b32 v65, a121
v_accvgpr_read_b32 v66, a122
v_accvgpr_read_b32 v67, a123
v_accvgpr_read_b32 v68, a124
v_accvgpr_read_b32 v69, a125
v_accvgpr_read_b32 v70, a126
v_accvgpr_read_b32 v71, a127
v_pk_mul_f32 v[64:65], v[64:65], v[12:13] op_sel_hi:[1,0]
v_pk_mul_f32 v[66:67], v[66:67], v[12:13] op_sel_hi:[1,0]
v_pk_mul_f32 v[68:69], v[68:69], v[12:13] op_sel_hi:[1,0]
v_pk_mul_f32 v[70:71], v[70:71], v[12:13] op_sel_hi:[1,0]
v_cvt_pk_bf16_f32 v236, v64, v65
v_cvt_pk_bf16_f32 v237, v66, v67
v_cvt_pk_bf16_f32 v238, v68, v69
v_cvt_pk_bf16_f32 v239, v70, v71
buffer_store_dwordx4 v[232:235], v95, s[16:19], s43 offen offset:2048 sc1
ds_write_b128 v3, v[232:235] offset:6144
buffer_store_dwordx4 v[236:239], v95, s[16:19], s43 offen offset:3072 sc1
ds_write_b128 v3, v[236:239] offset:7168
v_accvgpr_read_b32 v56, a128
v_accvgpr_read_b32 v57, a129
v_accvgpr_read_b32 v58, a130
v_accvgpr_read_b32 v59, a131
v_accvgpr_read_b32 v60, a132
v_accvgpr_read_b32 v61, a133
v_accvgpr_read_b32 v62, a134
v_accvgpr_read_b32 v63, a135
v_accvgpr_read_b32 v1, a176
v_accvgpr_read_b32 v12, a176
s_nop 1
v_permlane16_swap_b32 v1, v12
v_mov_b32 v12, v1
s_nop 1
v_permlane32_swap_b32 v1, v12
v_rcp_f32 v12, v1
v_cmp_le_f32 vcc, s30, v1
s_and_b64 s[44:45], s[44:45], vcc
v_cmp_ge_f32 vcc, s31, v1
s_and_b64 s[44:45], s[44:45], vcc
v_pk_mul_f32 v[56:57], v[56:57], v[12:13] op_sel_hi:[1,0]
v_pk_mul_f32 v[58:59], v[58:59], v[12:13] op_sel_hi:[1,0]
v_pk_mul_f32 v[60:61], v[60:61], v[12:13] op_sel_hi:[1,0]
v_pk_mul_f32 v[62:63], v[62:63], v[12:13] op_sel_hi:[1,0]
v_cvt_pk_bf16_f32 v240, v56, v57
v_cvt_pk_bf16_f32 v241, v58, v59
v_cvt_pk_bf16_f32 v242, v60, v61
v_cvt_pk_bf16_f32 v243, v62, v63
v_accvgpr_read_b32 v64, a136
v_accvgpr_read_b32 v65, a137
v_accvgpr_read_b32 v66, a138
v_accvgpr_read_b32 v67, a139
v_accvgpr_read_b32 v68, a140
v_accvgpr_read_b32 v69, a141
v_accvgpr_read_b32 v70, a142
v_accvgpr_read_b32 v71, a143
v_pk_mul_f32 v[64:65], v[64:65], v[12:13] op_sel_hi:[1,0]
v_pk_mul_f32 v[66:67], v[66:67], v[12:13] op_sel_hi:[1,0]
v_pk_mul_f32 v[68:69], v[68:69], v[12:13] op_sel_hi:[1,0]
v_pk_mul_f32 v[70:71], v[70:71], v[12:13] op_sel_hi:[1,0]
v_cvt_pk_bf16_f32 v244, v64, v65
v_cvt_pk_bf16_f32 v245, v66, v67
v_cvt_pk_bf16_f32 v246, v68, v69
v_cvt_pk_bf16_f32 v247, v70, v71
buffer_store_dwordx4 v[240:243], v94, s[16:19], s42 offen offset:0 sc1
ds_write_b128 v2, v[240:243] offset:8192
buffer_store_dwordx4 v[244:247], v94, s[16:19], s42 offen offset:1024 sc1
ds_write_b128 v2, v[244:247] offset:9216
v_accvgpr_read_b32 v56, a144
v_accvgpr_read_b32 v57, a145
v_accvgpr_read_b32 v58, a146
v_accvgpr_read_b32 v59, a147
v_accvgpr_read_b32 v60, a148
v_accvgpr_read_b32 v61, a149
v_accvgpr_read_b32 v62, a150
v_accvgpr_read_b32 v63, a151
v_pk_mul_f32 v[56:57], v[56:57], v[12:13] op_sel_hi:[1,0]
v_pk_mul_f32 v[58:59], v[58:59], v[12:13] op_sel_hi:[1,0]
v_pk_mul_f32 v[60:61], v[60:61], v[12:13] op_sel_hi:[1,0]
v_pk_mul_f32 v[62:63], v[62:63], v[12:13] op_sel_hi:[1,0]
v_cvt_pk_bf16_f32 v248, v56, v57
v_cvt_pk_bf16_f32 v249, v58, v59
v_cvt_pk_bf16_f32 v250, v60, v61
v_cvt_pk_bf16_f32 v251, v62, v63
v_accvgpr_read_b32 v64, a152
v_accvgpr_read_b32 v65, a153
v_accvgpr_read_b32 v66, a154
v_accvgpr_read_b32 v67, a155
v_accvgpr_read_b32 v68, a156
v_accvgpr_read_b32 v69, a157
v_accvgpr_read_b32 v70, a158
v_accvgpr_read_b32 v71, a159
v_pk_mul_f32 v[64:65], v[64:65], v[12:13] op_sel_hi:[1,0]
v_pk_mul_f32 v[66:67], v[66:67], v[12:13] op_sel_hi:[1,0]
v_pk_mul_f32 v[68:69], v[68:69], v[12:13] op_sel_hi:[1,0]
v_pk_mul_f32 v[70:71], v[70:71], v[12:13] op_sel_hi:[1,0]
v_cvt_pk_bf16_f32 v252, v64, v65
v_cvt_pk_bf16_f32 v253, v66, v67
v_cvt_pk_bf16_f32 v254, v68, v69
v_cvt_pk_bf16_f32 v255, v70, v71
buffer_store_dwordx4 v[248:251], v94, s[16:19], s43 offen offset:0 sc1
ds_write_b128 v3, v[248:251] offset:8192
buffer_store_dwordx4 v[252:255], v94, s[16:19], s43 offen offset:1024 sc1
ds_write_b128 v3, v[252:255] offset:9216
s_waitcnt vmcnt(16)
v_readfirstlane_b32 s28, v13
s_cmp_lt_u32 s28, 4
s_cselect_b32 s28, 1, 0
s_lshl_b32 s29, s20, 2
s_add_u32 s29, s29, 163776
v_mov_b32 v63, s29
v_mov_b32 v56, s28
v_mov_b32 v61, 163776
ds_write_b32 v63, v56 offset:16
s_waitcnt lgkmcnt(0)
s_barrier
ds_read_b128 v[56:59], v61 offset:16
ds_read_b64_tr_b16 a[40:41], v8 offset:0
ds_read_b128 a[0:3], v4 offset:0
ds_read_b64_tr_b16 a[42:43], v8 offset:1024
ds_read_b64_tr_b16 a[44:45], v9 offset:0
ds_read_b128 a[4:7], v4 offset:2048
ds_read_b64_tr_b16 a[46:47], v9 offset:1024
ds_read_b64_tr_b16 a[48:49], v10 offset:0
ds_read_b128 a[8:11], v4 offset:4096
ds_read_b64_tr_b16 a[50:51], v10 offset:1024
ds_read_b64_tr_b16 a[52:53], v11 offset:0
ds_read_b128 a[12:15], v4 offset:6144
ds_read_b64_tr_b16 a[54:55], v11 offset:1024
ds_read_b64_tr_b16 a[56:57], v8 offset:8192
ds_read_b128 a[16:19], v4 offset:8192
ds_read_b64_tr_b16 a[58:59], v8 offset:9216
ds_read_b64_tr_b16 a[60:61], v9 offset:8192
ds_read_b128 a[20:23], v5 offset:0
ds_read_b64_tr_b16 a[62:63], v9 offset:9216
ds_read_b64_tr_b16 a[64:65], v10 offset:8192
ds_read_b128 a[24:27], v5 offset:2048
ds_read_b64_tr_b16 a[66:67], v10 offset:9216
ds_read_b64_tr_b16 a[68:69], v11 offset:8192
ds_read_b128 a[28:31], v5 offset:4096
ds_read_b64_tr_b16 a[70:71], v11 offset:9216
ds_read_b128 a[32:35], v5 offset:6144
ds_read_b128 a[36:39], v5 offset:8192
v_mfma_f32_16x16x32_bf16 v[64:67], v[180:183], v[176:179], 0
v_lshlrev_b32 v1, 3, v54
v_add_u32 v1, v1, v55
v_mfma_f32_16x16x32_bf16 v[64:67], v[188:191], v[184:187], v[64:67]
v_lshlrev_b32 v1, 7, v1
v_mov_b32 v12, 1
v_mfma_f32_16x16x32_bf16 v[64:67], v[196:199], v[192:195], v[64:67]
s_lshl_b32 s28, s27, 5
s_lshl_b32 s29, s25, 2
v_mfma_f32_16x16x32_bf16 v[64:67], v[204:207], v[200:203], v[64:67]
s_add_u32 s28, s28, s29
s_lshl_b32 s28, s28, 7
v_mfma_f32_16x16x32_bf16 v[64:67], v[212:215], v[208:211], v[64:67]
s_lshl_b32 s29, s23, 2
s_add_u32 s28, s28, s29
v_mfma_f32_16x16x32_bf16 v[64:67], v[220:223], v[216:219], v[64:67]
s_add_u32 s48, s28, 25165824
s_andn2_b32 s31, s65, 3
v_mfma_f32_16x16x32_bf16 v[64:67], v[228:231], v[224:227], v[64:67]
s_lshr_b32 s31, s49, s31
s_and_b32 s31, s31, 15
v_mfma_f32_16x16x32_bf16 v[64:67], v[236:239], v[232:235], v[64:67]
s_add_u32 s28, s65, s64
s_and_b32 s28, s28, 3
v_mfma_f32_16x16x32_bf16 v[64:67], v[244:247], v[240:243], v[64:67]
s_lshl2_add_u32 s28, s31, s28
s_lshl_b32 s30, s28, 17
v_mfma_f32_16x16x32_bf16 v[64:67], v[252:255], v[248:251], v[64:67]
s_mul_i32 s29, s28, 20480
s_add_u32 s65, s65, 1
v_mov_b32 v62, 0x207
s_waitcnt lgkmcnt(15)
v_or3_b32 v56, v56, v57, v58
v_or_b32 v56, v56, v59
s_nop 0
v_readfirstlane_b32 s41, v56
s_cmp_lg_u32 s41, 0
s_cselect_b32 s6, 0, s6
v_add_f32 v64, v64, v65
v_add_f32 v66, v66, v67
v_add_f32 v64, v64, v66
v_cmp_class_f32 vcc, v64, v62
s_andn2_b64 s[44:45], s[44:45], vcc
s_cmp_eq_u64 s[44:45], -1
s_cselect_b32 s31, 0, 1
v_mov_b32 v56, s31
ds_write_b32 v63, v56
s_waitcnt lgkmcnt(0)
s_barrier
ds_read_b128 v[56:59], v61
s_mov_b32 s56, s29
v_mfma_f32_16x16x32_bf16 a[144:147], a[40:43], a[0:3], 0
s_add_u32 m0, s60, 0
ds_read_b64_tr_b16 a[112:113], v8 offset:16384
v_mfma_f32_16x16x32_bf16 a[144:147], a[56:59], a[20:23], a[144:147]
buffer_load_dwordx4 v14, s[4:7], s29 offen offset:0 sc1 lds
v_mfma_f32_16x16x32_bf16 a[160:163], a[56:59], a[24:27], 0
s_andn2_b32 s31, s65, 3
ds_read_b128 a[72:75], v4 offset:20480
v_mfma_f32_16x16x32_bf16 a[160:163], a[40:43], a[4:7], a[160:163]
ds_read_b64_tr_b16 a[114:115], v8 offset:17408
ds_read_b64_tr_b16 a[116:117], v9 offset:16384
v_mfma_f32_16x16x32_bf16 a[176:179], a[40:43], a[8:11], 0
ds_read_b128 a[76:79], v4 offset:22528
v_mfma_f32_16x16x32_bf16 a[176:179], a[56:59], a[28:31], a[176:179]
buffer_load_dwordx4 v15, s[4:7], s29 offen offset:1024 sc1 lds
v_mfma_f32_16x16x32_bf16 a[192:195], a[56:59], a[32:35], 0
s_lshr_b32 s31, s49, s31
ds_read_b64_tr_b16 a[118:119], v9 offset:17408
v_mfma_f32_16x16x32_bf16 a[192:195], a[40:43], a[12:15], a[192:195]
ds_read_b64_tr_b16 a[120:121], v10 offset:16384
v_mfma_f32_16x16x32_bf16 a[208:211], a[40:43], a[16:19], 0
ds_read_b128 a[80:83], v4 offset:24576
v_mfma_f32_16x16x32_bf16 a[208:211], a[56:59], a[36:39], a[208:211]
buffer_load_dwordx4 v16, s[4:7], s29 offen offset:2048 sc1 lds
v_mfma_f32_16x16x32_bf16 a[212:215], a[60:63], a[36:39], 0
s_and_b32 s31, s31, 15
ds_read_b64_tr_b16 a[122:123], v10 offset:17408
v_mfma_f32_16x16x32_bf16 a[212:215], a[44:47], a[16:19], a[212:215]
ds_read_b64_tr_b16 a[124:125], v11 offset:16384
ds_read_b128 a[84:87], v4 offset:26624
v_mfma_f32_16x16x32_bf16 a[196:199], a[44:47], a[12:15], 0
v_mfma_f32_16x16x32_bf16 a[196:199], a[60:63], a[32:35], a[196:199]
buffer_load_dwordx4 v17, s[4:7], s29 offen offset:3072 sc1 lds
v_mfma_f32_16x16x32_bf16 a[180:183], a[60:63], a[28:31], 0
s_add_u32 m0, s60, 4096
s_add_u32 s28, s65, s64
v_mfma_f32_16x16x32_bf16 a[180:183], a[44:47], a[8:11], a[180:183]
ds_read_b64_tr_b16 a[126:127], v11 offset:17408
ds_read_b64_tr_b16 a[128:129], v8 offset:24576
v_mfma_f32_16x16x32_bf16 a[164:167], a[44:47], a[4:7], 0
ds_read_b128 a[88:91], v4 offset:28672
ds_read_b64_tr_b16 a[130:131], v8 offset:25600
v_mfma_f32_16x16x32_bf16 a[164:167], a[60:63], a[24:27], a[164:167]
buffer_load_dwordx4 v18, s[4:7], s29 offen sc1 lds
v_mfma_f32_16x16x32_bf16 a[148:151], a[60:63], a[20:23], 0
s_add_u32 m0, s61, 0
s_and_b32 s28, s28, 3
v_mfma_f32_16x16x32_bf16 a[148:151], a[44:47], a[0:3], a[148:151]
ds_read_b64_tr_b16 a[132:133], v9 offset:24576
ds_read_b128 a[92:95], v5 offset:20480
v_mfma_f32_16x16x32_bf16 a[152:155], a[48:51], a[0:3], 0
s_lshl2_add_u32 s28, s31, s28
ds_read_b64_tr_b16 a[134:135], v9 offset:25600
v_mfma_f32_16x16x32_bf16 a[152:155], a[64:67], a[20:23], a[152:155]
buffer_load_dwordx4 v19, s[8:11], s30 offen offset:0 lds
v_mfma_f32_16x16x32_bf16 a[168:171], a[64:67], a[24:27], 0
ds_read_b64_tr_b16 a[136:137], v10 offset:24576
ds_read_b128 a[96:99], v5 offset:22528
v_mfma_f32_16x16x32_bf16 a[168:171], a[48:51], a[4:7], a[168:171]
ds_read_b64_tr_b16 a[138:139], v10 offset:25600
v_mfma_f32_16x16x32_bf16 a[184:187], a[48:51], a[8:11], 0
s_lshl_b32 s45, s28, 17
v_mfma_f32_16x16x32_bf16 a[184:187], a[64:67], a[28:31], a[184:187]
buffer_load_dwordx4 v20, s[8:11], s30 offen offset:1024 lds
v_mfma_f32_16x16x32_bf16 a[200:203], a[64:67], a[32:35], 0
ds_read_b64_tr_b16 a[140:141], v11 offset:24576
ds_read_b128 a[100:103], v5 offset:24576
v_mfma_f32_16x16x32_bf16 a[200:203], a[48:51], a[12:15], a[200:203]
ds_read_b64_tr_b16 a[142:143], v11 offset:25600
v_mfma_f32_16x16x32_bf16 a[216:219], a[48:51], a[16:19], 0
s_mul_i32 s44, s28, 20480
ds_read_b128 a[104:107], v5 offset:26624
v_mfma_f32_16x16x32_bf16 a[216:219], a[64:67], a[36:39], a[216:219]
buffer_load_dwordx4 v21, s[8:11], s30 offen offset:2048 lds
v_mfma_f32_16x16x32_bf16 a[220:223], a[68:71], a[36:39], 0
ds_read_b128 a[108:111], v5 offset:28672
v_mfma_f32_16x16x32_bf16 a[220:223], a[52:55], a[16:19], a[220:223]
v_mfma_f32_16x16x32_bf16 a[204:207], a[52:55], a[12:15], 0
s_add_u32 s65, s65, 1
v_mfma_f32_16x16x32_bf16 a[204:207], a[68:71], a[32:35], a[204:207]
buffer_load_dwordx4 v22, s[8:11], s30 offen offset:3072 lds
v_mfma_f32_16x16x32_bf16 a[188:191], a[68:71], a[28:31], 0
v_mfma_f32_16x16x32_bf16 a[188:191], a[52:55], a[8:11], a[188:191]
v_mfma_f32_16x16x32_bf16 a[172:175], a[52:55], a[4:7], 0
v_mfma_f32_16x16x32_bf16 a[172:175], a[68:71], a[24:27], a[172:175]
v_mfma_f32_16x16x32_bf16 a[156:159], a[68:71], a[20:23], 0
v_mfma_f32_16x16x32_bf16 a[156:159], a[52:55], a[0:3], a[156:159]
s_waitcnt vmcnt(9) lgkmcnt(0)
s_barrier
v_or3_b32 v56, v56, v57, v58
v_or_b32 v56, v56, v59
s_nop 0
v_readfirstlane_b32 s28, v56
s_cmp_gt_u32 s28, s36
s_cbranch_scc1 L_fallback
s_cmp_lg_u32 s20, 0
s_cbranch_scc1 L_osig_skip
s_mov_b64 exec, s[100:101]
buffer_atomic_add v12, v1, s[16:19], s48 offen sc1
s_mov_b64 exec, -1
L_osig_skip:
s_mov_b32 s57, s44
v_mfma_f32_16x16x32_bf16 a[144:147], a[112:115], a[72:75], a[144:147]
s_add_u32 m0, s60, 20480
ds_read_b64_tr_b16 a[40:41], v8 offset:32768
v_mfma_f32_16x16x32_bf16 a[144:147], a[128:131], a[92:95], a[144:147]
buffer_load_dwordx4 v14, s[4:7], s44 offen offset:0 sc1 lds
v_mfma_f32_16x16x32_bf16 a[160:163], a[128:131], a[96:99], a[160:163]
s_andn2_b32 s31, s65, 3
ds_read_b128 a[0:3], v6 offset:0
v_mfma_f32_16x16x32_bf16 a[160:163], a[112:115], a[76:79], a[160:163]
ds_read_b64_tr_b16 a[42:43], v8 offset:33792
ds_read_b64_tr_b16 a[44:45], v9 offset:32768
v_mfma_f32_16x16x32_bf16 a[176:179], a[112:115], a[80:83], a[176:179]
ds_read_b128 a[4:7], v6 offset:2048
v_mfma_f32_16x16x32_bf16 a[176:179], a[128:131], a[100:103], a[176:179]
buffer_load_dwordx4 v15, s[4:7], s44 offen offset:1024 sc1 lds
v_mfma_f32_16x16x32_bf16 a[192:195], a[128:131], a[104:107], a[192:195]
s_lshr_b32 s31, s49, s31
ds_read_b64_tr_b16 a[46:47], v9 offset:33792
v_mfma_f32_16x16x32_bf16 a[192:195], a[112:115], a[84:87], a[192:195]
ds_read_b64_tr_b16 a[48:49], v10 offset:32768
v_mfma_f32_16x16x32_bf16 a[208:211], a[112:115], a[88:91], a[208:211]
ds_read_b128 a[8:11], v6 offset:4096
v_mfma_f32_16x16x32_bf16 a[208:211], a[128:131], a[108:111], a[208:211]
buffer_load_dwordx4 v16, s[4:7], s44 offen offset:2048 sc1 lds
v_mfma_f32_16x16x32_bf16 a[212:215], a[132:135], a[108:111], a[212:215]
s_and_b32 s31, s31, 15
ds_read_b64_tr_b16 a[50:51], v10 offset:33792
v_mfma_f32_16x16x32_bf16 a[212:215], a[116:119], a[88:91], a[212:215]
ds_read_b64_tr_b16 a[52:53], v11 offset:32768
ds_read_b128 a[12:15], v6 offset:6144
v_mfma_f32_16x16x32_bf16 a[196:199], a[116:119], a[84:87], a[196:199]
v_mfma_f32_16x16x32_bf16 a[196:199], a[132:135], a[104:107], a[196:199]
buffer_load_dwordx4 v17, s[4:7], s44 offen offset:3072 sc1 lds
v_mfma_f32_16x16x32_bf16 a[180:183], a[132:135], a[100:103], a[180:183]
s_add_u32 m0, s60, 24576
s_add_u32 s28, s65, s64
v_mfma_f32_16x16x32_bf16 a[180:183], a[116:119], a[80:83], a[180:183]
ds_read_b64_tr_b16 a[54:55], v11 offset:33792
ds_read_b64_tr_b16 a[56:57], v8 offset:40960
v_mfma_f32_16x16x32_bf16 a[164:167], a[116:119], a[76:79], a[164:167]
ds_read_b128 a[16:19], v6 offset:8192
ds_read_b64_tr_b16 a[58:59], v8 offset:41984
v_mfma_f32_16x16x32_bf16 a[164:167], a[132:135], a[96:99], a[164:167]
buffer_load_dwordx4 v18, s[4:7], s44 offen sc1 lds
v_mfma_f32_16x16x32_bf16 a[148:151], a[132:135], a[92:95], a[148:151]
s_add_u32 m0, s61, 16384
s_and_b32 s28, s28, 3
v_mfma_f32_16x16x32_bf16 a[148:151], a[116:119], a[72:75], a[148:151]
ds_read_b64_tr_b16 a[60:61], v9 offset:40960
ds_read_b128 a[20:23], v7 offset:0
v_mfma_f32_16x16x32_bf16 a[152:155], a[120:123], a[72:75], a[152:155]
s_lshl2_add_u32 s28, s31, s28
ds_read_b64_tr_b16 a[62:63], v9 offset:41984
v_mfma_f32_16x16x32_bf16 a[152:155], a[136:139], a[92:95], a[152:155]
buffer_load_dwordx4 v19, s[8:11], s45 offen offset:0 lds
v_mfma_f32_16x16x32_bf16 a[168:171], a[136:139], a[96:99], a[168:171]
ds_read_b64_tr_b16 a[64:65], v10 offset:40960
ds_read_b128 a[24:27], v7 offset:2048
v_mfma_f32_16x16x32_bf16 a[168:171], a[120:123], a[76:79], a[168:171]
ds_read_b64_tr_b16 a[66:67], v10 offset:41984
v_mfma_f32_16x16x32_bf16 a[184:187], a[120:123], a[80:83], a[184:187]
s_lshl_b32 s30, s28, 17
v_mfma_f32_16x16x32_bf16 a[184:187], a[136:139], a[100:103], a[184:187]
buffer_load_dwordx4 v20, s[8:11], s45 offen offset:1024 lds
v_mfma_f32_16x16x32_bf16 a[200:203], a[136:139], a[104:107], a[200:203]
ds_read_b64_tr_b16 a[68:69], v11 offset:40960
ds_read_b128 a[28:31], v7 offset:4096
v_mfma_f32_16x16x32_bf16 a[200:203], a[120:123], a[84:87], a[200:203]
ds_read_b64_tr_b16 a[70:71], v11 offset:41984
v_mfma_f32_16x16x32_bf16 a[216:219], a[120:123], a[88:91], a[216:219]
s_mul_i32 s29, s28, 20480
ds_read_b128 a[32:35], v7 offset:6144
v_mfma_f32_16x16x32_bf16 a[216:219], a[136:139], a[108:111], a[216:219]
buffer_load_dwordx4 v21, s[8:11], s45 offen offset:2048 lds
v_mfma_f32_16x16x32_bf16 a[220:223], a[140:143], a[108:111], a[220:223]
ds_read_b128 a[36:39], v7 offset:8192
v_mfma_f32_16x16x32_bf16 a[220:223], a[124:127], a[88:91], a[220:223]
v_mfma_f32_16x16x32_bf16 a[204:207], a[124:127], a[84:87], a[204:207]
s_add_u32 s65, s65, 1
v_mfma_f32_16x16x32_bf16 a[204:207], a[140:143], a[104:107], a[204:207]
buffer_load_dwordx4 v22, s[8:11], s45 offen offset:3072 lds
v_mfma_f32_16x16x32_bf16 a[188:191], a[140:143], a[100:103], a[188:191]
v_mfma_f32_16x16x32_bf16 a[188:191], a[124:127], a[80:83], a[188:191]
v_mfma_f32_16x16x32_bf16 a[172:175], a[124:127], a[76:79], a[172:175]
v_mfma_f32_16x16x32_bf16 a[172:175], a[140:143], a[96:99], a[172:175]
v_mfma_f32_16x16x32_bf16 a[156:159], a[140:143], a[92:95], a[156:159]
v_mfma_f32_16x16x32_bf16 a[156:159], a[124:127], a[72:75], a[156:159]
s_waitcnt lgkmcnt(0)
s_barrier
s_mov_b32 s47, s29
buffer_load_dword v13, off, s[16:19], s50 sc1
v_mfma_f32_16x16x32_bf16 a[144:147], a[40:43], a[0:3], a[144:147]
s_add_u32 m0, s60, 40960
ds_read_b64_tr_b16 a[112:113], v8 offset:49152
v_mfma_f32_16x16x32_bf16 a[144:147], a[56:59], a[20:23], a[144:147]
buffer_load_dwordx4 v14, s[4:7], s29 offen offset:0 sc1 lds
v_mfma_f32_16x16x32_bf16 a[160:163], a[56:59], a[24:27], a[160:163]
s_andn2_b32 s31, s65, 3
ds_read_b128 a[72:75], v6 offset:20480
v_mfma_f32_16x16x32_bf16 a[160:163], a[40:43], a[4:7], a[160:163]
ds_read_b64_tr_b16 a[114:115], v8 offset:50176
ds_read_b64_tr_b16 a[116:117], v9 offset:49152
v_mfma_f32_16x16x32_bf16 a[176:179], a[40:43], a[8:11], a[176:179]
ds_read_b128 a[76:79], v6 offset:22528
v_mfma_f32_16x16x32_bf16 a[176:179], a[56:59], a[28:31], a[176:179]
buffer_load_dwordx4 v15, s[4:7], s29 offen offset:1024 sc1 lds
v_mfma_f32_16x16x32_bf16 a[192:195], a[56:59], a[32:35], a[192:195]
s_lshr_b32 s31, s49, s31
ds_read_b64_tr_b16 a[118:119], v9 offset:50176
v_mfma_f32_16x16x32_bf16 a[192:195], a[40:43], a[12:15], a[192:195]
ds_read_b64_tr_b16 a[120:121], v10 offset:49152
v_mfma_f32_16x16x32_bf16 a[208:211], a[40:43], a[16:19], a[208:211]
ds_read_b128 a[80:83], v6 offset:24576
v_mfma_f32_16x16x32_bf16 a[208:211], a[56:59], a[36:39], a[208:211]
buffer_load_dwordx4 v16, s[4:7], s29 offen offset:2048 sc1 lds
v_mfma_f32_16x16x32_bf16 a[212:215], a[60:63], a[36:39], a[212:215]
s_and_b32 s31, s31, 15
ds_read_b64_tr_b16 a[122:123], v10 offset:50176
v_mfma_f32_16x16x32_bf16 a[212:215], a[44:47], a[16:19], a[212:215]
ds_read_b64_tr_b16 a[124:125], v11 offset:49152
ds_read_b128 a[84:87], v6 offset:26624
v_mfma_f32_16x16x32_bf16 a[196:199], a[44:47], a[12:15], a[196:199]
v_mfma_f32_16x16x32_bf16 a[196:199], a[60:63], a[32:35], a[196:199]
buffer_load_dwordx4 v17, s[4:7], s29 offen offset:3072 sc1 lds
v_mfma_f32_16x16x32_bf16 a[180:183], a[60:63], a[28:31], a[180:183]
s_add_u32 m0, s60, 45056
s_add_u32 s28, s65, s64
v_mfma_f32_16x16x32_bf16 a[180:183], a[44:47], a[8:11], a[180:183]
ds_read_b64_tr_b16 a[126:127], v11 offset:50176
ds_read_b64_tr_b16 a[128:129], v8 offset:57344
v_mfma_f32_16x16x32_bf16 a[164:167], a[44:47], a[4:7], a[164:167]
ds_read_b128 a[88:91], v6 offset:28672
ds_read_b64_tr_b16 a[130:131], v8 offset:58368
v_mfma_f32_16x16x32_bf16 a[164:167], a[60:63], a[24:27], a[164:167]
buffer_load_dwordx4 v18, s[4:7], s29 offen sc1 lds
v_mfma_f32_16x16x32_bf16 a[148:151], a[60:63], a[20:23], a[148:151]
s_add_u32 m0, s61, 32768
s_and_b32 s28, s28, 3
v_mfma_f32_16x16x32_bf16 a[148:151], a[44:47], a[0:3], a[148:151]
ds_read_b64_tr_b16 a[132:133], v9 offset:57344
ds_read_b128 a[92:95], v7 offset:20480
v_mfma_f32_16x16x32_bf16 a[152:155], a[48:51], a[0:3], a[152:155]
s_lshl2_add_u32 s28, s31, s28
ds_read_b64_tr_b16 a[134:135], v9 offset:58368
v_mfma_f32_16x16x32_bf16 a[152:155], a[64:67], a[20:23], a[152:155]
buffer_load_dwordx4 v19, s[8:11], s30 offen offset:0 lds
v_mfma_f32_16x16x32_bf16 a[168:171], a[64:67], a[24:27], a[168:171]
ds_read_b64_tr_b16 a[136:137], v10 offset:57344
ds_read_b128 a[96:99], v7 offset:22528
v_mfma_f32_16x16x32_bf16 a[168:171], a[48:51], a[4:7], a[168:171]
ds_read_b64_tr_b16 a[138:139], v10 offset:58368
v_mfma_f32_16x16x32_bf16 a[184:187], a[48:51], a[8:11], a[184:187]
s_lshl_b32 s45, s28, 17
v_mfma_f32_16x16x32_bf16 a[184:187], a[64:67], a[28:31], a[184:187]
buffer_load_dwordx4 v20, s[8:11], s30 offen offset:1024 lds
v_mfma_f32_16x16x32_bf16 a[200:203], a[64:67], a[32:35], a[200:203]
ds_read_b64_tr_b16 a[140:141], v11 offset:57344
ds_read_b128 a[100:103], v7 offset:24576
v_mfma_f32_16x16x32_bf16 a[200:203], a[48:51], a[12:15], a[200:203]
ds_read_b64_tr_b16 a[142:143], v11 offset:58368
v_mfma_f32_16x16x32_bf16 a[216:219], a[48:51], a[16:19], a[216:219]
s_mul_i32 s44, s28, 20480
ds_read_b128 a[104:107], v7 offset:26624
v_mfma_f32_16x16x32_bf16 a[216:219], a[64:67], a[36:39], a[216:219]
buffer_load_dwordx4 v21, s[8:11], s30 offen offset:2048 lds
v_mfma_f32_16x16x32_bf16 a[220:223], a[68:71], a[36:39], a[220:223]
ds_read_b128 a[108:111], v7 offset:28672
v_mfma_f32_16x16x32_bf16 a[220:223], a[52:55], a[16:19], a[220:223]
v_mfma_f32_16x16x32_bf16 a[204:207], a[52:55], a[12:15], a[204:207]
s_add_u32 s65, s65, 1
v_mfma_f32_16x16x32_bf16 a[204:207], a[68:71], a[32:35], a[204:207]
buffer_load_dwordx4 v22, s[8:11], s30 offen offset:3072 lds
v_mfma_f32_16x16x32_bf16 a[188:191], a[68:71], a[28:31], a[188:191]
v_mfma_f32_16x16x32_bf16 a[188:191], a[52:55], a[8:11], a[188:191]
v_mfma_f32_16x16x32_bf16 a[172:175], a[52:55], a[4:7], a[172:175]
v_mfma_f32_16x16x32_bf16 a[172:175], a[68:71], a[24:27], a[172:175]
v_mfma_f32_16x16x32_bf16 a[156:159], a[68:71], a[20:23], a[156:159]
v_mfma_f32_16x16x32_bf16 a[156:159], a[52:55], a[0:3], a[156:159]
s_waitcnt vmcnt(18) lgkmcnt(0)
s_barrier
s_cmp_lg_u32 s6, 0
s_cbranch_scc1 L_mid_skip
s_waitcnt vmcnt(4)
v_readfirstlane_b32 s42, v13
s_cmp_lt_u32 s42, 4
s_cbranch_scc1 L_mid_skip
s_mov_b32 s6, 1310720
s_add_u32 m0, s60, 0
s_nop 0
buffer_load_dwordx4 v14, s[4:7], s56 offen offset:0 sc1 lds
buffer_load_dwordx4 v15, s[4:7], s56 offen offset:1024 sc1 lds
buffer_load_dwordx4 v16, s[4:7], s56 offen offset:2048 sc1 lds
buffer_load_dwordx4 v17, s[4:7], s56 offen offset:3072 sc1 lds
s_add_u32 m0, s60, 4096
s_nop 0
buffer_load_dwordx4 v18, s[4:7], s56 offen sc1 lds
s_add_u32 m0, s60, 20480
s_nop 0
buffer_load_dwordx4 v14, s[4:7], s57 offen offset:0 sc1 lds
buffer_load_dwordx4 v15, s[4:7], s57 offen offset:1024 sc1 lds
buffer_load_dwordx4 v16, s[4:7], s57 offen offset:2048 sc1 lds
buffer_load_dwordx4 v17, s[4:7], s57 offen offset:3072 sc1 lds
s_add_u32 m0, s60, 24576
s_nop 0
buffer_load_dwordx4 v18, s[4:7], s57 offen sc1 lds
s_add_u32 m0, s60, 40960
s_nop 0
buffer_load_dwordx4 v14, s[4:7], s47 offen offset:0 sc1 lds
buffer_load_dwordx4 v15, s[4:7], s47 offen offset:1024 sc1 lds
buffer_load_dwordx4 v16, s[4:7], s47 offen offset:2048 sc1 lds
buffer_load_dwordx4 v17, s[4:7], s47 offen offset:3072 sc1 lds
s_add_u32 m0, s60, 45056
s_nop 0
buffer_load_dwordx4 v18, s[4:7], s47 offen sc1 lds
L_mid_skip:
buffer_load_dword v13, off, s[16:19], s50 sc1
v_mfma_f32_16x16x32_bf16 a[144:147], a[112:115], a[72:75], a[144:147]
s_add_u32 m0, s60, 61440
ds_read_b64_tr_b16 a[40:41], v8 offset:0
v_mfma_f32_16x16x32_bf16 a[144:147], a[128:131], a[92:95], a[144:147]
buffer_load_dwordx4 v14, s[4:7], s44 offen offset:0 sc1 lds
v_mfma_f32_16x16x32_bf16 a[160:163], a[128:131], a[96:99], a[160:163]
s_andn2_b32 s31, s65, 3
ds_read_b128 a[0:3], v4 offset:0
v_mfma_f32_16x16x32_bf16 a[160:163], a[112:115], a[76:79], a[160:163]
ds_read_b64_tr_b16 a[42:43], v8 offset:1024
ds_read_b64_tr_b16 a[44:45], v9 offset:0
v_mfma_f32_16x16x32_bf16 a[176:179], a[112:115], a[80:83], a[176:179]
ds_read_b128 a[4:7], v4 offset:2048
v_mfma_f32_16x16x32_bf16 a[176:179], a[128:131], a[100:103], a[176:179]
buffer_load_dwordx4 v15, s[4:7], s44 offen offset:1024 sc1 lds
v_mfma_f32_16x16x32_bf16 a[192:195], a[128:131], a[104:107], a[192:195]
s_lshr_b32 s31, s49, s31
ds_read_b64_tr_b16 a[46:47], v9 offset:1024
v_mfma_f32_16x16x32_bf16 a[192:195], a[112:115], a[84:87], a[192:195]
ds_read_b64_tr_b16 a[48:49], v10 offset:0
v_mfma_f32_16x16x32_bf16 a[208:211], a[112:115], a[88:91], a[208:211]
ds_read_b128 a[8:11], v4 offset:4096
v_mfma_f32_16x16x32_bf16 a[208:211], a[128:131], a[108:111], a[208:211]
buffer_load_dwordx4 v16, s[4:7], s44 offen offset:2048 sc1 lds
v_mfma_f32_16x16x32_bf16 a[212:215], a[132:135], a[108:111], a[212:215]
s_and_b32 s31, s31, 15
ds_read_b64_tr_b16 a[50:51], v10 offset:1024
v_mfma_f32_16x16x32_bf16 a[212:215], a[116:119], a[88:91], a[212:215]
ds_read_b64_tr_b16 a[52:53], v11 offset:0
ds_read_b128 a[12:15], v4 offset:6144
v_mfma_f32_16x16x32_bf16 a[196:199], a[116:119], a[84:87], a[196:199]
v_mfma_f32_16x16x32_bf16 a[196:199], a[132:135], a[104:107], a[196:199]
buffer_load_dwordx4 v17, s[4:7], s44 offen offset:3072 sc1 lds
v_mfma_f32_16x16x32_bf16 a[180:183], a[132:135], a[100:103], a[180:183]
s_add_u32 m0, s60, 65536
s_add_u32 s28, s65, s64
v_mfma_f32_16x16x32_bf16 a[180:183], a[116:119], a[80:83], a[180:183]
ds_read_b64_tr_b16 a[54:55], v11 offset:1024
ds_read_b64_tr_b16 a[56:57], v8 offset:8192
v_mfma_f32_16x16x32_bf16 a[164:167], a[116:119], a[76:79], a[164:167]
ds_read_b128 a[16:19], v4 offset:8192
ds_read_b64_tr_b16 a[58:59], v8 offset:9216
v_mfma_f32_16x16x32_bf16 a[164:167], a[132:135], a[96:99], a[164:167]
buffer_load_dwordx4 v18, s[4:7], s44 offen sc1 lds
v_mfma_f32_16x16x32_bf16 a[148:151], a[132:135], a[92:95], a[148:151]
s_add_u32 m0, s61, 49152
s_and_b32 s28, s28, 3
v_mfma_f32_16x16x32_bf16 a[148:151], a[116:119], a[72:75], a[148:151]
ds_read_b64_tr_b16 a[60:61], v9 offset:8192
ds_read_b128 a[20:23], v5 offset:0
v_mfma_f32_16x16x32_bf16 a[152:155], a[120:123], a[72:75], a[152:155]
s_lshl2_add_u32 s28, s31, s28
ds_read_b64_tr_b16 a[62:63], v9 offset:9216
v_mfma_f32_16x16x32_bf16 a[152:155], a[136:139], a[92:95], a[152:155]
buffer_load_dwordx4 v19, s[8:11], s45 offen offset:0 lds
v_mfma_f32_16x16x32_bf16 a[168:171], a[136:139], a[96:99], a[168:171]
ds_read_b64_tr_b16 a[64:65], v10 offset:8192
ds_read_b128 a[24:27], v5 offset:2048
v_mfma_f32_16x16x32_bf16 a[168:171], a[120:123], a[76:79], a[168:171]
ds_read_b64_tr_b16 a[66:67], v10 offset:9216
v_mfma_f32_16x16x32_bf16 a[184:187], a[120:123], a[80:83], a[184:187]
s_lshl_b32 s30, s28, 17
v_mfma_f32_16x16x32_bf16 a[184:187], a[136:139], a[100:103], a[184:187]
buffer_load_dwordx4 v20, s[8:11], s45 offen offset:1024 lds
v_mfma_f32_16x16x32_bf16 a[200:203], a[136:139], a[104:107], a[200:203]
ds_read_b64_tr_b16 a[68:69], v11 offset:8192
ds_read_b128 a[28:31], v5 offset:4096
v_mfma_f32_16x16x32_bf16 a[200:203], a[120:123], a[84:87], a[200:203]
ds_read_b64_tr_b16 a[70:71], v11 offset:9216
v_mfma_f32_16x16x32_bf16 a[216:219], a[120:123], a[88:91], a[216:219]
s_mul_i32 s29, s28, 20480
ds_read_b128 a[32:35], v5 offset:6144
v_mfma_f32_16x16x32_bf16 a[216:219], a[136:139], a[108:111], a[216:219]
buffer_load_dwordx4 v21, s[8:11], s45 offen offset:2048 lds
v_mfma_f32_16x16x32_bf16 a[220:223], a[140:143], a[108:111], a[220:223]
ds_read_b128 a[36:39], v5 offset:8192
v_mfma_f32_16x16x32_bf16 a[220:223], a[124:127], a[88:91], a[220:223]
v_mfma_f32_16x16x32_bf16 a[204:207], a[124:127], a[84:87], a[204:207]
s_add_u32 s65, s65, 1
v_mfma_f32_16x16x32_bf16 a[204:207], a[140:143], a[104:107], a[204:207]
buffer_load_dwordx4 v22, s[8:11], s45 offen offset:3072 lds
v_mfma_f32_16x16x32_bf16 a[188:191], a[140:143], a[100:103], a[188:191]
v_mfma_f32_16x16x32_bf16 a[188:191], a[124:127], a[80:83], a[188:191]
v_mfma_f32_16x16x32_bf16 a[172:175], a[124:127], a[76:79], a[172:175]
v_mfma_f32_16x16x32_bf16 a[172:175], a[140:143], a[96:99], a[172:175]
v_mfma_f32_16x16x32_bf16 a[156:159], a[140:143], a[92:95], a[156:159]
v_mfma_f32_16x16x32_bf16 a[156:159], a[124:127], a[72:75], a[156:159]
s_waitcnt vmcnt(19) lgkmcnt(0)
s_barrier
s_cmp_eq_u32 s41, 0
s_cbranch_scc1 L_go_enter
s_cmp_lg_u32 s6, 0
s_cbranch_scc1 L_haveB
s_waitcnt vmcnt(4)
v_readfirstlane_b32 s42, v13
s_cmp_ge_u32 s42, 4
s_cbranch_scc1 L_keep
s_mov_b32 s43, 0
L_pl1:
buffer_load_dword v13, off, s[16:19], s50 offset:0 sc1
s_add_u32 s43, s43, 1
s_waitcnt vmcnt(0)
v_readfirstlane_b32 s42, v13
s_cmp_ge_u32 s43, 16777216
s_cbranch_scc1 L_pld1
s_cmp_lt_u32 s42, 4
s_cbranch_scc1 L_pl1
L_pld1:
L_keep:
s_mov_b32 s6, 1310720
s_add_u32 m0, s60, 0
s_nop 0
buffer_load_dwordx4 v14, s[4:7], s56 offen offset:0 sc1 lds
buffer_load_dwordx4 v15, s[4:7], s56 offen offset:1024 sc1 lds
buffer_load_dwordx4 v16, s[4:7], s56 offen offset:2048 sc1 lds
buffer_load_dwordx4 v17, s[4:7], s56 offen offset:3072 sc1 lds
s_add_u32 m0, s60, 4096
s_nop 0
buffer_load_dwordx4 v18, s[4:7], s56 offen sc1 lds
s_add_u32 m0, s60, 20480
s_nop 0
buffer_load_dwordx4 v14, s[4:7], s57 offen offset:0 sc1 lds
buffer_load_dwordx4 v15, s[4:7], s57 offen offset:1024 sc1 lds
buffer_load_dwordx4 v16, s[4:7], s57 offen offset:2048 sc1 lds
buffer_load_dwordx4 v17, s[4:7], s57 offen offset:3072 sc1 lds
s_add_u32 m0, s60, 24576
s_nop 0
buffer_load_dwordx4 v18, s[4:7], s57 offen sc1 lds
s_add_u32 m0, s60, 40960
s_nop 0
buffer_load_dwordx4 v14, s[4:7], s47 offen offset:0 sc1 lds
buffer_load_dwordx4 v15, s[4:7], s47 offen offset:1024 sc1 lds
buffer_load_dwordx4 v16, s[4:7], s47 offen offset:2048 sc1 lds
buffer_load_dwordx4 v17, s[4:7], s47 offen offset:3072 sc1 lds
s_add_u32 m0, s60, 45056
s_nop 0
buffer_load_dwordx4 v18, s[4:7], s47 offen sc1 lds
s_add_u32 m0, s60, 61440
s_nop 0
buffer_load_dwordx4 v14, s[4:7], s44 offen offset:0 sc1 lds
buffer_load_dwordx4 v15, s[4:7], s44 offen offset:1024 sc1 lds
buffer_load_dwordx4 v16, s[4:7], s44 offen offset:2048 sc1 lds
buffer_load_dwordx4 v17, s[4:7], s44 offen offset:3072 sc1 lds
s_add_u32 m0, s60, 65536
s_nop 0
buffer_load_dwordx4 v18, s[4:7], s44 offen sc1 lds
s_waitcnt vmcnt(15)
s_barrier
ds_read_b64_tr_b16 a[40:41], v8 offset:0
ds_read_b128 a[0:3], v4 offset:0
ds_read_b64_tr_b16 a[42:43], v8 offset:1024
ds_read_b64_tr_b16 a[44:45], v9 offset:0
ds_read_b128 a[4:7], v4 offset:2048
ds_read_b64_tr_b16 a[46:47], v9 offset:1024
ds_read_b64_tr_b16 a[48:49], v10 offset:0
ds_read_b128 a[8:11], v4 offset:4096
ds_read_b64_tr_b16 a[50:51], v10 offset:1024
ds_read_b64_tr_b16 a[52:53], v11 offset:0
ds_read_b128 a[12:15], v4 offset:6144
ds_read_b64_tr_b16 a[54:55], v11 offset:1024
ds_read_b64_tr_b16 a[56:57], v8 offset:8192
ds_read_b128 a[16:19], v4 offset:8192
ds_read_b64_tr_b16 a[58:59], v8 offset:9216
ds_read_b64_tr_b16 a[60:61], v9 offset:8192
ds_read_b128 a[20:23], v5 offset:0
ds_read_b64_tr_b16 a[62:63], v9 offset:9216
ds_read_b64_tr_b16 a[64:65], v10 offset:8192
ds_read_b128 a[24:27], v5 offset:2048
ds_read_b64_tr_b16 a[66:67], v10 offset:9216
ds_read_b64_tr_b16 a[68:69], v11 offset:8192
ds_read_b128 a[28:31], v5 offset:4096
ds_read_b64_tr_b16 a[70:71], v11 offset:9216
ds_read_b128 a[32:35], v5 offset:6144
ds_read_b128 a[36:39], v5 offset:8192
s_waitcnt vmcnt(5) lgkmcnt(0)
s_barrier
s_branch L_go_enter
L_haveB:
s_barrier
ds_read_b64_tr_b16 a[40:41], v8 offset:0
ds_read_b128 a[0:3], v4 offset:0
ds_read_b64_tr_b16 a[42:43], v8 offset:1024
ds_read_b64_tr_b16 a[44:45], v9 offset:0
ds_read_b128 a[4:7], v4 offset:2048
ds_read_b64_tr_b16 a[46:47], v9 offset:1024
ds_read_b64_tr_b16 a[48:49], v10 offset:0
ds_read_b128 a[8:11], v4 offset:4096
ds_read_b64_tr_b16 a[50:51], v10 offset:1024
ds_read_b64_tr_b16 a[52:53], v11 offset:0
ds_read_b128 a[12:15], v4 offset:6144
ds_read_b64_tr_b16 a[54:55], v11 offset:1024
ds_read_b64_tr_b16 a[56:57], v8 offset:8192
ds_read_b128 a[16:19], v4 offset:8192
ds_read_b64_tr_b16 a[58:59], v8 offset:9216
ds_read_b64_tr_b16 a[60:61], v9 offset:8192
ds_read_b128 a[20:23], v5 offset:0
ds_read_b64_tr_b16 a[62:63], v9 offset:9216
ds_read_b64_tr_b16 a[64:65], v10 offset:8192
ds_read_b128 a[24:27], v5 offset:2048
ds_read_b64_tr_b16 a[66:67], v10 offset:9216
ds_read_b64_tr_b16 a[68:69], v11 offset:8192
ds_read_b128 a[28:31], v5 offset:4096
ds_read_b64_tr_b16 a[70:71], v11 offset:9216
ds_read_b128 a[32:35], v5 offset:6144
ds_read_b128 a[36:39], v5 offset:8192
s_waitcnt vmcnt(15) lgkmcnt(0)
s_barrier
L_go_enter:
s_branch L_go_loop_in
.p2align 3
L_go_loop:
v_mfma_f32_16x16x32_bf16 a[156:159], a[124:127], a[72:75], a[156:159]
s_waitcnt vmcnt(18) lgkmcnt(0)
s_barrier
L_go_loop_in:
v_mfma_f32_16x16x32_bf16 a[144:147], a[40:43], a[0:3], a[144:147]
s_add_u32 m0, s60, 0
ds_read_b64_tr_b16 a[112:113], v8 offset:16384
v_mfma_f32_16x16x32_bf16 a[144:147], a[56:59], a[20:23], a[144:147]
buffer_load_dwordx4 v14, s[4:7], s29 offen offset:0 sc1 lds
v_mfma_f32_16x16x32_bf16 a[160:163], a[56:59], a[24:27], a[160:163]
s_andn2_b32 s31, s65, 3
ds_read_b128 a[72:75], v4 offset:20480
v_mfma_f32_16x16x32_bf16 a[160:163], a[40:43], a[4:7], a[160:163]
ds_read_b64_tr_b16 a[114:115], v8 offset:17408
ds_read_b64_tr_b16 a[116:117], v9 offset:16384
v_mfma_f32_16x16x32_bf16 a[176:179], a[40:43], a[8:11], a[176:179]
ds_read_b128 a[76:79], v4 offset:22528
v_mfma_f32_16x16x32_bf16 a[176:179], a[56:59], a[28:31], a[176:179]
buffer_load_dwordx4 v15, s[4:7], s29 offen offset:1024 sc1 lds
v_mfma_f32_16x16x32_bf16 a[192:195], a[56:59], a[32:35], a[192:195]
s_lshr_b32 s31, s49, s31
ds_read_b64_tr_b16 a[118:119], v9 offset:17408
v_mfma_f32_16x16x32_bf16 a[192:195], a[40:43], a[12:15], a[192:195]
ds_read_b64_tr_b16 a[120:121], v10 offset:16384
v_mfma_f32_16x16x32_bf16 a[208:211], a[40:43], a[16:19], a[208:211]
ds_read_b128 a[80:83], v4 offset:24576
v_mfma_f32_16x16x32_bf16 a[208:211], a[56:59], a[36:39], a[208:211]
buffer_load_dwordx4 v16, s[4:7], s29 offen offset:2048 sc1 lds
v_mfma_f32_16x16x32_bf16 a[212:215], a[60:63], a[36:39], a[212:215]
s_and_b32 s31, s31, 15
ds_read_b64_tr_b16 a[122:123], v10 offset:17408
v_mfma_f32_16x16x32_bf16 a[212:215], a[44:47], a[16:19], a[212:215]
ds_read_b64_tr_b16 a[124:125], v11 offset:16384
ds_read_b128 a[84:87], v4 offset:26624
v_mfma_f32_16x16x32_bf16 a[196:199], a[44:47], a[12:15], a[196:199]
v_mfma_f32_16x16x32_bf16 a[196:199], a[60:63], a[32:35], a[196:199]
buffer_load_dwordx4 v17, s[4:7], s29 offen offset:3072 sc1 lds
v_mfma_f32_16x16x32_bf16 a[180:183], a[60:63], a[28:31], a[180:183]
s_add_u32 m0, s60, 4096
s_add_u32 s28, s65, s64
v_mfma_f32_16x16x32_bf16 a[180:183], a[44:47], a[8:11], a[180:183]
ds_read_b64_tr_b16 a[126:127], v11 offset:17408
ds_read_b64_tr_b16 a[128:129], v8 offset:24576
v_mfma_f32_16x16x32_bf16 a[164:167], a[44:47], a[4:7], a[164:167]
ds_read_b128 a[88:91], v4 offset:28672
ds_read_b64_tr_b16 a[130:131], v8 offset:25600
v_mfma_f32_16x16x32_bf16 a[164:167], a[60:63], a[24:27], a[164:167]
buffer_load_dwordx4 v18, s[4:7], s29 offen sc1 lds
v_mfma_f32_16x16x32_bf16 a[148:151], a[60:63], a[20:23], a[148:151]
s_add_u32 m0, s61, 0
s_and_b32 s28, s28, 3
v_mfma_f32_16x16x32_bf16 a[148:151], a[44:47], a[0:3], a[148:151]
ds_read_b64_tr_b16 a[132:133], v9 offset:24576
ds_read_b128 a[92:95], v5 offset:20480
v_mfma_f32_16x16x32_bf16 a[152:155], a[48:51], a[0:3], a[152:155]
s_lshl2_add_u32 s28, s31, s28
ds_read_b64_tr_b16 a[134:135], v9 offset:25600
v_mfma_f32_16x16x32_bf16 a[152:155], a[64:67], a[20:23], a[152:155]
buffer_load_dwordx4 v19, s[8:11], s30 offen offset:0 lds
v_mfma_f32_16x16x32_bf16 a[168:171], a[64:67], a[24:27], a[168:171]
ds_read_b64_tr_b16 a[136:137], v10 offset:24576
ds_read_b128 a[96:99], v5 offset:22528
v_mfma_f32_16x16x32_bf16 a[168:171], a[48:51], a[4:7], a[168:171]
ds_read_b64_tr_b16 a[138:139], v10 offset:25600
v_mfma_f32_16x16x32_bf16 a[184:187], a[48:51], a[8:11], a[184:187]
s_lshl_b32 s45, s28, 17
v_mfma_f32_16x16x32_bf16 a[184:187], a[64:67], a[28:31], a[184:187]
buffer_load_dwordx4 v20, s[8:11], s30 offen offset:1024 lds
v_mfma_f32_16x16x32_bf16 a[200:203], a[64:67], a[32:35], a[200:203]
ds_read_b64_tr_b16 a[140:141], v11 offset:24576
ds_read_b128 a[100:103], v5 offset:24576
v_mfma_f32_16x16x32_bf16 a[200:203], a[48:51], a[12:15], a[200:203]
ds_read_b64_tr_b16 a[142:143], v11 offset:25600
v_mfma_f32_16x16x32_bf16 a[216:219], a[48:51], a[16:19], a[216:219]
s_mul_i32 s44, s28, 20480
ds_read_b128 a[104:107], v5 offset:26624
v_mfma_f32_16x16x32_bf16 a[216:219], a[64:67], a[36:39], a[216:219]
buffer_load_dwordx4 v21, s[8:11], s30 offen offset:2048 lds
v_mfma_f32_16x16x32_bf16 a[220:223], a[68:71], a[36:39], a[220:223]
ds_read_b128 a[108:111], v5 offset:28672
v_mfma_f32_16x16x32_bf16 a[220:223], a[52:55], a[16:19], a[220:223]
v_mfma_f32_16x16x32_bf16 a[204:207], a[52:55], a[12:15], a[204:207]
s_add_u32 s65, s65, 1
v_mfma_f32_16x16x32_bf16 a[204:207], a[68:71], a[32:35], a[204:207]
buffer_load_dwordx4 v22, s[8:11], s30 offen offset:3072 lds
v_mfma_f32_16x16x32_bf16 a[188:191], a[68:71], a[28:31], a[188:191]
v_mfma_f32_16x16x32_bf16 a[188:191], a[52:55], a[8:11], a[188:191]
v_mfma_f32_16x16x32_bf16 a[172:175], a[52:55], a[4:7], a[172:175]
v_mfma_f32_16x16x32_bf16 a[172:175], a[68:71], a[24:27], a[172:175]
v_mfma_f32_16x16x32_bf16 a[156:159], a[68:71], a[20:23], a[156:159]
v_mfma_f32_16x16x32_bf16 a[156:159], a[52:55], a[0:3], a[156:159]
s_waitcnt vmcnt(18) lgkmcnt(0)
s_barrier
v_mfma_f32_16x16x32_bf16 a[144:147], a[112:115], a[72:75], a[144:147]
s_add_u32 m0, s60, 20480
ds_read_b64_tr_b16 a[40:41], v8 offset:32768
v_mfma_f32_16x16x32_bf16 a[144:147], a[128:131], a[92:95], a[144:147]
buffer_load_dwordx4 v14, s[4:7], s44 offen offset:0 sc1 lds
v_mfma_f32_16x16x32_bf16 a[160:163], a[128:131], a[96:99], a[160:163]
s_andn2_b32 s31, s65, 3
ds_read_b128 a[0:3], v6 offset:0
v_mfma_f32_16x16x32_bf16 a[160:163], a[112:115], a[76:79], a[160:163]
ds_read_b64_tr_b16 a[42:43], v8 offset:33792
ds_read_b64_tr_b16 a[44:45], v9 offset:32768
v_mfma_f32_16x16x32_bf16 a[176:179], a[112:115], a[80:83], a[176:179]
ds_read_b128 a[4:7], v6 offset:2048
v_mfma_f32_16x16x32_bf16 a[176:179], a[128:131], a[100:103], a[176:179]
buffer_load_dwordx4 v15, s[4:7], s44 offen offset:1024 sc1 lds
v_mfma_f32_16x16x32_bf16 a[192:195], a[128:131], a[104:107], a[192:195]
s_lshr_b32 s31, s49, s31
ds_read_b64_tr_b16 a[46:47], v9 offset:33792
v_mfma_f32_16x16x32_bf16 a[192:195], a[112:115], a[84:87], a[192:195]
ds_read_b64_tr_b16 a[48:49], v10 offset:32768
v_mfma_f32_16x16x32_bf16 a[208:211], a[112:115], a[88:91], a[208:211]
ds_read_b128 a[8:11], v6 offset:4096
v_mfma_f32_16x16x32_bf16 a[208:211], a[128:131], a[108:111], a[208:211]
buffer_load_dwordx4 v16, s[4:7], s44 offen offset:2048 sc1 lds
v_mfma_f32_16x16x32_bf16 a[212:215], a[132:135], a[108:111], a[212:215]
s_and_b32 s31, s31, 15
ds_read_b64_tr_b16 a[50:51], v10 offset:33792
v_mfma_f32_16x16x32_bf16 a[212:215], a[116:119], a[88:91], a[212:215]
ds_read_b64_tr_b16 a[52:53], v11 offset:32768
ds_read_b128 a[12:15], v6 offset:6144
v_mfma_f32_16x16x32_bf16 a[196:199], a[116:119], a[84:87], a[196:199]
v_mfma_f32_16x16x32_bf16 a[196:199], a[132:135], a[104:107], a[196:199]
buffer_load_dwordx4 v17, s[4:7], s44 offen offset:3072 sc1 lds
v_mfma_f32_16x16x32_bf16 a[180:183], a[132:135], a[100:103], a[180:183]
s_add_u32 m0, s60, 24576
s_add_u32 s28, s65, s64
v_mfma_f32_16x16x32_bf16 a[180:183], a[116:119], a[80:83], a[180:183]
ds_read_b64_tr_b16 a[54:55], v11 offset:33792
ds_read_b64_tr_b16 a[56:57], v8 offset:40960
v_mfma_f32_16x16x32_bf16 a[164:167], a[116:119], a[76:79], a[164:167]
ds_read_b128 a[16:19], v6 offset:8192
ds_read_b64_tr_b16 a[58:59], v8 offset:41984
v_mfma_f32_16x16x32_bf16 a[164:167], a[132:135], a[96:99], a[164:167]
buffer_load_dwordx4 v18, s[4:7], s44 offen sc1 lds
v_mfma_f32_16x16x32_bf16 a[148:151], a[132:135], a[92:95], a[148:151]
s_add_u32 m0, s61, 16384
s_and_b32 s28, s28, 3
v_mfma_f32_16x16x32_bf16 a[148:151], a[116:119], a[72:75], a[148:151]
ds_read_b64_tr_b16 a[60:61], v9 offset:40960
ds_read_b128 a[20:23], v7 offset:0
v_mfma_f32_16x16x32_bf16 a[152:155], a[120:123], a[72:75], a[152:155]
s_lshl2_add_u32 s28, s31, s28
ds_read_b64_tr_b16 a[62:63], v9 offset:41984
v_mfma_f32_16x16x32_bf16 a[152:155], a[136:139], a[92:95], a[152:155]
buffer_load_dwordx4 v19, s[8:11], s45 offen offset:0 lds
v_mfma_f32_16x16x32_bf16 a[168:171], a[136:139], a[96:99], a[168:171]
ds_read_b64_tr_b16 a[64:65], v10 offset:40960
ds_read_b128 a[24:27], v7 offset:2048
v_mfma_f32_16x16x32_bf16 a[168:171], a[120:123], a[76:79], a[168:171]
ds_read_b64_tr_b16 a[66:67], v10 offset:41984
v_mfma_f32_16x16x32_bf16 a[184:187], a[120:123], a[80:83], a[184:187]
s_lshl_b32 s30, s28, 17
v_mfma_f32_16x16x32_bf16 a[184:187], a[136:139], a[100:103], a[184:187]
buffer_load_dwordx4 v20, s[8:11], s45 offen offset:1024 lds
v_mfma_f32_16x16x32_bf16 a[200:203], a[136:139], a[104:107], a[200:203]
ds_read_b64_tr_b16 a[68:69], v11 offset:40960
ds_read_b128 a[28:31], v7 offset:4096
v_mfma_f32_16x16x32_bf16 a[200:203], a[120:123], a[84:87], a[200:203]
ds_read_b64_tr_b16 a[70:71], v11 offset:41984
v_mfma_f32_16x16x32_bf16 a[216:219], a[120:123], a[88:91], a[216:219]
s_mul_i32 s29, s28, 20480
ds_read_b128 a[32:35], v7 offset:6144
v_mfma_f32_16x16x32_bf16 a[216:219], a[136:139], a[108:111], a[216:219]
buffer_load_dwordx4 v21, s[8:11], s45 offen offset:2048 lds
v_mfma_f32_16x16x32_bf16 a[220:223], a[140:143], a[108:111], a[220:223]
ds_read_b128 a[36:39], v7 offset:8192
v_mfma_f32_16x16x32_bf16 a[220:223], a[124:127], a[88:91], a[220:223]
v_mfma_f32_16x16x32_bf16 a[204:207], a[124:127], a[84:87], a[204:207]
s_add_u32 s65, s65, 1
v_mfma_f32_16x16x32_bf16 a[204:207], a[140:143], a[104:107], a[204:207]
buffer_load_dwordx4 v22, s[8:11], s45 offen offset:3072 lds
v_mfma_f32_16x16x32_bf16 a[188:191], a[140:143], a[100:103], a[188:191]
v_mfma_f32_16x16x32_bf16 a[188:191], a[124:127], a[80:83], a[188:191]
v_mfma_f32_16x16x32_bf16 a[172:175], a[124:127], a[76:79], a[172:175]
v_mfma_f32_16x16x32_bf16 a[172:175], a[140:143], a[96:99], a[172:175]
v_mfma_f32_16x16x32_bf16 a[156:159], a[140:143], a[92:95], a[156:159]
v_mfma_f32_16x16x32_bf16 a[156:159], a[124:127], a[72:75], a[156:159]
s_waitcnt vmcnt(18) lgkmcnt(0)
s_barrier
v_mfma_f32_16x16x32_bf16 a[144:147], a[40:43], a[0:3], a[144:147]
s_add_u32 m0, s60, 40960
ds_read_b64_tr_b16 a[112:113], v8 offset:49152
v_mfma_f32_16x16x32_bf16 a[144:147], a[56:59], a[20:23], a[144:147]
buffer_load_dwordx4 v14, s[4:7], s29 offen offset:0 sc1 lds
v_mfma_f32_16x16x32_bf16 a[160:163], a[56:59], a[24:27], a[160:163]
s_andn2_b32 s31, s65, 3
ds_read_b128 a[72:75], v6 offset:20480
v_mfma_f32_16x16x32_bf16 a[160:163], a[40:43], a[4:7], a[160:163]
ds_read_b64_tr_b16 a[114:115], v8 offset:50176
ds_read_b64_tr_b16 a[116:117], v9 offset:49152
v_mfma_f32_16x16x32_bf16 a[176:179], a[40:43], a[8:11], a[176:179]
ds_read_b128 a[76:79], v6 offset:22528
v_mfma_f32_16x16x32_bf16 a[176:179], a[56:59], a[28:31], a[176:179]
buffer_load_dwordx4 v15, s[4:7], s29 offen offset:1024 sc1 lds
v_mfma_f32_16x16x32_bf16 a[192:195], a[56:59], a[32:35], a[192:195]
s_lshr_b32 s31, s49, s31
ds_read_b64_tr_b16 a[118:119], v9 offset:50176
v_mfma_f32_16x16x32_bf16 a[192:195], a[40:43], a[12:15], a[192:195]
ds_read_b64_tr_b16 a[120:121], v10 offset:49152
v_mfma_f32_16x16x32_bf16 a[208:211], a[40:43], a[16:19], a[208:211]
ds_read_b128 a[80:83], v6 offset:24576
v_mfma_f32_16x16x32_bf16 a[208:211], a[56:59], a[36:39], a[208:211]
buffer_load_dwordx4 v16, s[4:7], s29 offen offset:2048 sc1 lds
v_mfma_f32_16x16x32_bf16 a[212:215], a[60:63], a[36:39], a[212:215]
s_and_b32 s31, s31, 15
ds_read_b64_tr_b16 a[122:123], v10 offset:50176
v_mfma_f32_16x16x32_bf16 a[212:215], a[44:47], a[16:19], a[212:215]
ds_read_b64_tr_b16 a[124:125], v11 offset:49152
ds_read_b128 a[84:87], v6 offset:26624
v_mfma_f32_16x16x32_bf16 a[196:199], a[44:47], a[12:15], a[196:199]
v_mfma_f32_16x16x32_bf16 a[196:199], a[60:63], a[32:35], a[196:199]
buffer_load_dwordx4 v17, s[4:7], s29 offen offset:3072 sc1 lds
v_mfma_f32_16x16x32_bf16 a[180:183], a[60:63], a[28:31], a[180:183]
s_add_u32 m0, s60, 45056
s_add_u32 s28, s65, s64
v_mfma_f32_16x16x32_bf16 a[180:183], a[44:47], a[8:11], a[180:183]
ds_read_b64_tr_b16 a[126:127], v11 offset:50176
ds_read_b64_tr_b16 a[128:129], v8 offset:57344
v_mfma_f32_16x16x32_bf16 a[164:167], a[44:47], a[4:7], a[164:167]
ds_read_b128 a[88:91], v6 offset:28672
ds_read_b64_tr_b16 a[130:131], v8 offset:58368
v_mfma_f32_16x16x32_bf16 a[164:167], a[60:63], a[24:27], a[164:167]
buffer_load_dwordx4 v18, s[4:7], s29 offen sc1 lds
v_mfma_f32_16x16x32_bf16 a[148:151], a[60:63], a[20:23], a[148:151]
s_add_u32 m0, s61, 32768
s_and_b32 s28, s28, 3
v_mfma_f32_16x16x32_bf16 a[148:151], a[44:47], a[0:3], a[148:151]
ds_read_b64_tr_b16 a[132:133], v9 offset:57344
ds_read_b128 a[92:95], v7 offset:20480
v_mfma_f32_16x16x32_bf16 a[152:155], a[48:51], a[0:3], a[152:155]
s_lshl2_add_u32 s28, s31, s28
ds_read_b64_tr_b16 a[134:135], v9 offset:58368
v_mfma_f32_16x16x32_bf16 a[152:155], a[64:67], a[20:23], a[152:155]
buffer_load_dwordx4 v19, s[8:11], s30 offen offset:0 lds
v_mfma_f32_16x16x32_bf16 a[168:171], a[64:67], a[24:27], a[168:171]
ds_read_b64_tr_b16 a[136:137], v10 offset:57344
ds_read_b128 a[96:99], v7 offset:22528
v_mfma_f32_16x16x32_bf16 a[168:171], a[48:51], a[4:7], a[168:171]
ds_read_b64_tr_b16 a[138:139], v10 offset:58368
v_mfma_f32_16x16x32_bf16 a[184:187], a[48:51], a[8:11], a[184:187]
s_lshl_b32 s45, s28, 17
v_mfma_f32_16x16x32_bf16 a[184:187], a[64:67], a[28:31], a[184:187]
buffer_load_dwordx4 v20, s[8:11], s30 offen offset:1024 lds
v_mfma_f32_16x16x32_bf16 a[200:203], a[64:67], a[32:35], a[200:203]
ds_read_b64_tr_b16 a[140:141], v11 offset:57344
ds_read_b128 a[100:103], v7 offset:24576
v_mfma_f32_16x16x32_bf16 a[200:203], a[48:51], a[12:15], a[200:203]
ds_read_b64_tr_b16 a[142:143], v11 offset:58368
v_mfma_f32_16x16x32_bf16 a[216:219], a[48:51], a[16:19], a[216:219]
s_mul_i32 s44, s28, 20480
ds_read_b128 a[104:107], v7 offset:26624
v_mfma_f32_16x16x32_bf16 a[216:219], a[64:67], a[36:39], a[216:219]
buffer_load_dwordx4 v21, s[8:11], s30 offen offset:2048 lds
v_mfma_f32_16x16x32_bf16 a[220:223], a[68:71], a[36:39], a[220:223]
ds_read_b128 a[108:111], v7 offset:28672
v_mfma_f32_16x16x32_bf16 a[220:223], a[52:55], a[16:19], a[220:223]
v_mfma_f32_16x16x32_bf16 a[204:207], a[52:55], a[12:15], a[204:207]
s_add_u32 s65, s65, 1
v_mfma_f32_16x16x32_bf16 a[204:207], a[68:71], a[32:35], a[204:207]
buffer_load_dwordx4 v22, s[8:11], s30 offen offset:3072 lds
v_mfma_f32_16x16x32_bf16 a[188:191], a[68:71], a[28:31], a[188:191]
v_mfma_f32_16x16x32_bf16 a[188:191], a[52:55], a[8:11], a[188:191]
v_mfma_f32_16x16x32_bf16 a[172:175], a[52:55], a[4:7], a[172:175]
v_mfma_f32_16x16x32_bf16 a[172:175], a[68:71], a[24:27], a[172:175]
v_mfma_f32_16x16x32_bf16 a[156:159], a[68:71], a[20:23], a[156:159]
v_mfma_f32_16x16x32_bf16 a[156:159], a[52:55], a[0:3], a[156:159]
s_waitcnt vmcnt(18) lgkmcnt(0)
s_barrier
v_mfma_f32_16x16x32_bf16 a[144:147], a[112:115], a[72:75], a[144:147]
s_add_u32 m0, s60, 61440
ds_read_b64_tr_b16 a[40:41], v8 offset:0
v_mfma_f32_16x16x32_bf16 a[144:147], a[128:131], a[92:95], a[144:147]
buffer_load_dwordx4 v14, s[4:7], s44 offen offset:0 sc1 lds
v_mfma_f32_16x16x32_bf16 a[160:163], a[128:131], a[96:99], a[160:163]
s_andn2_b32 s31, s65, 3
ds_read_b128 a[0:3], v4 offset:0
v_mfma_f32_16x16x32_bf16 a[160:163], a[112:115], a[76:79], a[160:163]
ds_read_b64_tr_b16 a[42:43], v8 offset:1024
ds_read_b64_tr_b16 a[44:45], v9 offset:0
v_mfma_f32_16x16x32_bf16 a[176:179], a[112:115], a[80:83], a[176:179]
ds_read_b128 a[4:7], v4 offset:2048
v_mfma_f32_16x16x32_bf16 a[176:179], a[128:131], a[100:103], a[176:179]
buffer_load_dwordx4 v15, s[4:7], s44 offen offset:1024 sc1 lds
v_mfma_f32_16x16x32_bf16 a[192:195], a[128:131], a[104:107], a[192:195]
s_lshr_b32 s31, s49, s31
ds_read_b64_tr_b16 a[46:47], v9 offset:1024
v_mfma_f32_16x16x32_bf16 a[192:195], a[112:115], a[84:87], a[192:195]
ds_read_b64_tr_b16 a[48:49], v10 offset:0
v_mfma_f32_16x16x32_bf16 a[208:211], a[112:115], a[88:91], a[208:211]
ds_read_b128 a[8:11], v4 offset:4096
v_mfma_f32_16x16x32_bf16 a[208:211], a[128:131], a[108:111], a[208:211]
buffer_load_dwordx4 v16, s[4:7], s44 offen offset:2048 sc1 lds
v_mfma_f32_16x16x32_bf16 a[212:215], a[132:135], a[108:111], a[212:215]
s_and_b32 s31, s31, 15
ds_read_b64_tr_b16 a[50:51], v10 offset:1024
v_mfma_f32_16x16x32_bf16 a[212:215], a[116:119], a[88:91], a[212:215]
ds_read_b64_tr_b16 a[52:53], v11 offset:0
ds_read_b128 a[12:15], v4 offset:6144
v_mfma_f32_16x16x32_bf16 a[196:199], a[116:119], a[84:87], a[196:199]
v_mfma_f32_16x16x32_bf16 a[196:199], a[132:135], a[104:107], a[196:199]
buffer_load_dwordx4 v17, s[4:7], s44 offen offset:3072 sc1 lds
v_mfma_f32_16x16x32_bf16 a[180:183], a[132:135], a[100:103], a[180:183]
s_add_u32 m0, s60, 65536
s_add_u32 s28, s65, s64
v_mfma_f32_16x16x32_bf16 a[180:183], a[116:119], a[80:83], a[180:183]
ds_read_b64_tr_b16 a[54:55], v11 offset:1024
ds_read_b64_tr_b16 a[56:57], v8 offset:8192
v_mfma_f32_16x16x32_bf16 a[164:167], a[116:119], a[76:79], a[164:167]
ds_read_b128 a[16:19], v4 offset:8192
ds_read_b64_tr_b16 a[58:59], v8 offset:9216
v_mfma_f32_16x16x32_bf16 a[164:167], a[132:135], a[96:99], a[164:167]
buffer_load_dwordx4 v18, s[4:7], s44 offen sc1 lds
v_mfma_f32_16x16x32_bf16 a[148:151], a[132:135], a[92:95], a[148:151]
s_add_u32 m0, s61, 49152
s_and_b32 s28, s28, 3
v_mfma_f32_16x16x32_bf16 a[148:151], a[116:119], a[72:75], a[148:151]
ds_read_b64_tr_b16 a[60:61], v9 offset:8192
ds_read_b128 a[20:23], v5 offset:0
v_mfma_f32_16x16x32_bf16 a[152:155], a[120:123], a[72:75], a[152:155]
s_lshl2_add_u32 s28, s31, s28
ds_read_b64_tr_b16 a[62:63], v9 offset:9216
v_mfma_f32_16x16x32_bf16 a[152:155], a[136:139], a[92:95], a[152:155]
buffer_load_dwordx4 v19, s[8:11], s45 offen offset:0 lds
v_mfma_f32_16x16x32_bf16 a[168:171], a[136:139], a[96:99], a[168:171]
ds_read_b64_tr_b16 a[64:65], v10 offset:8192
ds_read_b128 a[24:27], v5 offset:2048
v_mfma_f32_16x16x32_bf16 a[168:171], a[120:123], a[76:79], a[168:171]
ds_read_b64_tr_b16 a[66:67], v10 offset:9216
v_mfma_f32_16x16x32_bf16 a[184:187], a[120:123], a[80:83], a[184:187]
s_lshl_b32 s30, s28, 17
v_mfma_f32_16x16x32_bf16 a[184:187], a[136:139], a[100:103], a[184:187]
buffer_load_dwordx4 v20, s[8:11], s45 offen offset:1024 lds
v_mfma_f32_16x16x32_bf16 a[200:203], a[136:139], a[104:107], a[200:203]
ds_read_b64_tr_b16 a[68:69], v11 offset:8192
ds_read_b128 a[28:31], v5 offset:4096
v_mfma_f32_16x16x32_bf16 a[200:203], a[120:123], a[84:87], a[200:203]
ds_read_b64_tr_b16 a[70:71], v11 offset:9216
v_mfma_f32_16x16x32_bf16 a[216:219], a[120:123], a[88:91], a[216:219]
s_mul_i32 s29, s28, 20480
ds_read_b128 a[32:35], v5 offset:6144
v_mfma_f32_16x16x32_bf16 a[216:219], a[136:139], a[108:111], a[216:219]
buffer_load_dwordx4 v21, s[8:11], s45 offen offset:2048 lds
v_mfma_f32_16x16x32_bf16 a[220:223], a[140:143], a[108:111], a[220:223]
ds_read_b128 a[36:39], v5 offset:8192
v_mfma_f32_16x16x32_bf16 a[220:223], a[124:127], a[88:91], a[220:223]
v_mfma_f32_16x16x32_bf16 a[204:207], a[124:127], a[84:87], a[204:207]
s_add_u32 s65, s65, 1
v_mfma_f32_16x16x32_bf16 a[204:207], a[140:143], a[104:107], a[204:207]
buffer_load_dwordx4 v22, s[8:11], s45 offen offset:3072 lds
v_mfma_f32_16x16x32_bf16 a[188:191], a[140:143], a[100:103], a[188:191]
v_mfma_f32_16x16x32_bf16 a[188:191], a[124:127], a[80:83], a[188:191]
v_mfma_f32_16x16x32_bf16 a[172:175], a[124:127], a[76:79], a[172:175]
v_mfma_f32_16x16x32_bf16 a[172:175], a[140:143], a[96:99], a[172:175]
s_cmp_lt_u32 s65, s38
v_mfma_f32_16x16x32_bf16 a[156:159], a[140:143], a[92:95], a[156:159]
s_cbranch_scc1 L_go_loop
s_cmp_ge_u32 s65, 33
s_cbranch_scc1 L_go_done
s_cmp_eq_u32 s65, s37
s_cbranch_scc1 L_go_chk
s_cmp_lt_u32 s65, s37
s_cbranch_scc1 L_go_smp
s_mov_b32 s38, 33
s_getpc_b64 s[56:57]
L_pcd:
s_mov_b32 s58, L_code_end-L_pcd
s_mov_b32 s59, 0x20000
v_lshrrev_b32 v56, 5, v0
s_lshr_b32 s28, s2, 3
s_lshl_b32 s28, s28, 10
v_lshlrev_b32 v56, 7, v56
buffer_load_dword v57, v56, s[56:59], s28 offen
s_branch L_go_loop
L_go_smp:
buffer_load_dword v13, off, s[16:19], s51 sc1
s_branch L_go_loop
L_go_chk:
s_mov_b32 s38, 25
v_readfirstlane_b32 s42, v13
s_cmp_ge_u32 s42, 4
s_cbranch_scc1 L_go_loop
s_mov_b32 s43, 0
L_pl2:
buffer_load_dword v13, off, s[16:19], s51 offset:0 sc1
s_add_u32 s43, s43, 1
s_waitcnt vmcnt(0)
v_readfirstlane_b32 s42, v13
s_cmp_ge_u32 s43, 16777216
s_cbranch_scc1 L_pld2
s_cmp_lt_u32 s42, 4
s_cbranch_scc1 L_pl2
L_pld2:
s_branch L_go_loop
L_go_done:
v_mfma_f32_16x16x32_bf16 a[156:159], a[124:127], a[72:75], a[156:159]
s_waitcnt vmcnt(18) lgkmcnt(0)
s_barrier
v_mfma_f32_16x16x32_bf16 a[152:155], a[48:51], a[0:3], a[152:155]
ds_read_b64_tr_b16 a[120:121], v10 offset:16384
ds_read_b128 a[72:75], v4 offset:20480
v_mfma_f32_16x16x32_bf16 a[152:155], a[64:67], a[20:23], a[152:155]
ds_read_b64_tr_b16 a[122:123], v10 offset:17408
s_lshl_b32 s28, s2, 2
v_mfma_f32_16x16x32_bf16 a[168:171], a[64:67], a[24:27], a[168:171]
ds_read_b64_tr_b16 a[124:125], v11 offset:16384
ds_read_b128 a[76:79], v4 offset:22528
v_mfma_f32_16x16x32_bf16 a[168:171], a[48:51], a[4:7], a[168:171]
ds_read_b64_tr_b16 a[126:127], v11 offset:17408
s_add_u32 s28, s28, s20
v_mfma_f32_16x16x32_bf16 a[184:187], a[48:51], a[8:11], a[184:187]
ds_read_b64_tr_b16 a[136:137], v10 offset:24576
s_xor_b32 s29, s28, 4
v_mfma_f32_16x16x32_bf16 a[184:187], a[64:67], a[28:31], a[184:187]
ds_read_b128 a[80:83], v4 offset:24576
ds_read_b64_tr_b16 a[138:139], v10 offset:25600
v_mfma_f32_16x16x32_bf16 a[200:203], a[64:67], a[32:35], a[200:203]
ds_read_b64_tr_b16 a[140:141], v11 offset:24576
s_mul_i32 s48, s28, 10240
v_mfma_f32_16x16x32_bf16 a[200:203], a[48:51], a[12:15], a[200:203]
ds_read_b128 a[84:87], v4 offset:26624
ds_read_b64_tr_b16 a[142:143], v11 offset:25600
v_mfma_f32_16x16x32_bf16 a[216:219], a[48:51], a[16:19], a[216:219]
ds_read_b128 a[88:91], v4 offset:28672
s_add_u32 s48, s48, 26214400
v_mfma_f32_16x16x32_bf16 a[216:219], a[64:67], a[36:39], a[216:219]
ds_read_b128 a[92:95], v5 offset:20480
s_mul_i32 s49, s29, 10240
v_mfma_f32_16x16x32_bf16 a[220:223], a[68:71], a[36:39], a[220:223]
ds_read_b128 a[96:99], v5 offset:22528
ds_read_b128 a[100:103], v5 offset:24576
v_mfma_f32_16x16x32_bf16 a[220:223], a[52:55], a[16:19], a[220:223]
ds_read_b128 a[104:107], v5 offset:26624
s_add_u32 s49, s49, 26214400
v_mfma_f32_16x16x32_bf16 a[204:207], a[52:55], a[12:15], a[204:207]
ds_read_b128 a[108:111], v5 offset:28672
s_mul_i32 s28, s27, 160
v_mfma_f32_16x16x32_bf16 a[204:207], a[68:71], a[32:35], a[204:207]
s_mul_i32 s29, s22, 80
s_add_u32 s28, s28, s29
v_mfma_f32_16x16x32_bf16 a[188:191], a[68:71], a[28:31], a[188:191]
s_lshl_b32 s28, s28, 12
s_lshl_b32 s29, s25, 11
v_mfma_f32_16x16x32_bf16 a[188:191], a[52:55], a[8:11], a[188:191]
s_add_u32 s28, s28, s29
s_add_u32 s28, s28, s24
v_mfma_f32_16x16x32_bf16 a[172:175], a[52:55], a[4:7], a[172:175]
s_add_u32 s12, s52, s28
s_addc_u32 s13, s53, 0
v_mfma_f32_16x16x32_bf16 a[172:175], a[68:71], a[24:27], a[172:175]
s_mov_b32 s14, 323648
s_mov_b32 s15, 0x20000
v_mfma_f32_16x16x32_bf16 a[156:159], a[68:71], a[20:23], a[156:159]
s_lshl_b32 s28, s20, 2
s_add_u32 s50, s39, s28
v_mfma_f32_16x16x32_bf16 a[156:159], a[52:55], a[0:3], a[156:159]
s_xor_b32 s51, s50, 128
v_lshrrev_b32 v1, 1, v53
s_waitcnt vmcnt(9) lgkmcnt(0)
s_barrier
v_mfma_f32_16x16x32_bf16 a[152:155], a[120:123], a[72:75], a[152:155]
ds_read_b64_tr_b16 v[144:145], v10 offset:32768
ds_read_b128 v[96:99], v6 offset:0
v_mfma_f32_16x16x32_bf16 a[152:155], a[136:139], a[92:95], a[152:155]
ds_read_b64_tr_b16 v[146:147], v10 offset:33792
v_and_b32 v3, 1, v53
v_mfma_f32_16x16x32_bf16 a[168:171], a[136:139], a[96:99], a[168:171]
ds_read_b64_tr_b16 v[148:149], v11 offset:32768
ds_read_b128 v[100:103], v6 offset:2048
v_mfma_f32_16x16x32_bf16 a[168:171], a[120:123], a[76:79], a[168:171]
ds_read_b64_tr_b16 v[150:151], v11 offset:33792
v_lshl_or_b32 v1, v3, 1, v1
v_mfma_f32_16x16x32_bf16 a[184:187], a[120:123], a[80:83], a[184:187]
ds_read_b64_tr_b16 v[160:161], v10 offset:40960
v_lshlrev_b32 v1, 4, v1
v_mfma_f32_16x16x32_bf16 a[184:187], a[136:139], a[100:103], a[184:187]
ds_read_b128 v[104:107], v6 offset:4096
ds_read_b64_tr_b16 v[162:163], v10 offset:41984
v_mfma_f32_16x16x32_bf16 a[200:203], a[136:139], a[104:107], a[200:203]
ds_read_b64_tr_b16 v[164:165], v11 offset:40960
v_lshl_add_u32 v1, v52, 12, v1
v_mfma_f32_16x16x32_bf16 a[200:203], a[120:123], a[84:87], a[200:203]
ds_read_b128 v[108:111], v6 offset:6144
ds_read_b64_tr_b16 v[166:167], v11 offset:41984
v_mfma_f32_16x16x32_bf16 a[216:219], a[120:123], a[88:91], a[216:219]
ds_read_b128 v[112:115], v6 offset:8192
v_mfma_f32_16x16x32_bf16 a[216:219], a[136:139], a[108:111], a[216:219]
ds_read_b128 v[116:119], v7 offset:0
v_mfma_f32_16x16x32_bf16 a[220:223], a[140:143], a[108:111], a[220:223]
ds_read_b128 v[120:123], v7 offset:2048
ds_read_b128 v[124:127], v7 offset:4096
v_mfma_f32_16x16x32_bf16 a[220:223], a[124:127], a[88:91], a[220:223]
ds_read_b128 v[128:131], v7 offset:6144
v_mfma_f32_16x16x32_bf16 a[204:207], a[124:127], a[84:87], a[204:207]
ds_read_b128 v[132:135], v7 offset:8192
v_mfma_f32_16x16x32_bf16 a[204:207], a[140:143], a[104:107], a[204:207]
v_mfma_f32_16x16x32_bf16 a[188:191], a[140:143], a[100:103], a[188:191]
v_mfma_f32_16x16x32_bf16 a[188:191], a[124:127], a[80:83], a[188:191]
v_mfma_f32_16x16x32_bf16 a[172:175], a[124:127], a[76:79], a[172:175]
v_mfma_f32_16x16x32_bf16 a[172:175], a[140:143], a[96:99], a[172:175]
v_mfma_f32_16x16x32_bf16 a[156:159], a[140:143], a[92:95], a[156:159]
v_mfma_f32_16x16x32_bf16 a[156:159], a[124:127], a[72:75], a[156:159]
s_waitcnt vmcnt(0) lgkmcnt(0)
s_barrier
v_mfma_f32_16x16x32_bf16 a[144:147], a[40:43], a[0:3], a[144:147]
ds_read_b64_tr_b16 v[216:217], v10 offset:49152
ds_read_b128 v[168:171], v6 offset:20480
v_mfma_f32_16x16x32_bf16 a[144:147], a[56:59], a[20:23], a[144:147]
ds_read_b64_tr_b16 v[218:219], v10 offset:50176
v_mfma_f32_16x16x32_bf16 a[160:163], a[56:59], a[24:27], a[160:163]
ds_read_b64_tr_b16 v[220:221], v11 offset:49152
ds_read_b128 v[172:175], v6 offset:22528
v_mfma_f32_16x16x32_bf16 a[160:163], a[40:43], a[4:7], a[160:163]
ds_read_b64_tr_b16 v[222:223], v11 offset:50176
v_mfma_f32_16x16x32_bf16 a[176:179], a[40:43], a[8:11], a[176:179]
ds_read_b64_tr_b16 v[232:233], v10 offset:57344
v_mfma_f32_16x16x32_bf16 a[176:179], a[56:59], a[28:31], a[176:179]
ds_read_b128 v[176:179], v6 offset:24576
ds_read_b64_tr_b16 v[234:235], v10 offset:58368
v_mfma_f32_16x16x32_bf16 a[192:195], a[56:59], a[32:35], a[192:195]
ds_read_b64_tr_b16 v[236:237], v11 offset:57344
v_mfma_f32_16x16x32_bf16 a[192:195], a[40:43], a[12:15], a[192:195]
ds_read_b128 v[180:183], v6 offset:26624
ds_read_b64_tr_b16 v[238:239], v11 offset:58368
v_mfma_f32_16x16x32_bf16 a[208:211], a[40:43], a[16:19], a[208:211]
ds_read_b128 v[184:187], v6 offset:28672
v_mfma_f32_16x16x32_bf16 a[208:211], a[56:59], a[36:39], a[208:211]
ds_read_b128 v[188:191], v7 offset:20480
v_mfma_f32_16x16x32_bf16 a[212:215], a[60:63], a[36:39], a[212:215]
ds_read_b128 v[192:195], v7 offset:22528
ds_read_b128 v[196:199], v7 offset:24576
v_mfma_f32_16x16x32_bf16 a[212:215], a[44:47], a[16:19], a[212:215]
ds_read_b128 v[200:203], v7 offset:26624
v_mfma_f32_16x16x32_bf16 a[196:199], a[44:47], a[12:15], a[196:199]
ds_read_b128 v[204:207], v7 offset:28672
v_mfma_f32_16x16x32_bf16 a[196:199], a[60:63], a[32:35], a[196:199]
v_mfma_f32_16x16x32_bf16 a[180:183], a[60:63], a[28:31], a[180:183]
v_mfma_f32_16x16x32_bf16 a[180:183], a[44:47], a[8:11], a[180:183]
v_mfma_f32_16x16x32_bf16 a[164:167], a[44:47], a[4:7], a[164:167]
v_mfma_f32_16x16x32_bf16 a[164:167], a[60:63], a[24:27], a[164:167]
v_mfma_f32_16x16x32_bf16 a[148:151], a[60:63], a[20:23], a[148:151]
v_mfma_f32_16x16x32_bf16 a[148:151], a[44:47], a[0:3], a[148:151]
s_waitcnt lgkmcnt(0)
v_mfma_f32_16x16x32_bf16 a[152:155], v[144:147], v[96:99], a[152:155]
ds_read_b64_tr_b16 a[112:113], v8 offset:16384
v_mfma_f32_16x16x32_bf16 a[152:155], v[160:163], v[116:119], a[152:155]
ds_read_b64_tr_b16 a[114:115], v8 offset:17408
v_mfma_f32_16x16x32_bf16 a[152:155], v[216:219], v[168:171], a[152:155]
ds_read_b64_tr_b16 a[116:117], v9 offset:16384
v_mfma_f32_16x16x32_bf16 a[152:155], v[232:235], v[188:191], a[152:155]
ds_read_b64_tr_b16 a[118:119], v9 offset:17408
v_mfma_f32_16x16x32_bf16 a[168:171], v[160:163], v[120:123], a[168:171]
v_mfma_f32_16x16x32_bf16 a[168:171], v[144:147], v[100:103], a[168:171]
ds_read_b64_tr_b16 a[128:129], v8 offset:24576
v_mfma_f32_16x16x32_bf16 a[168:171], v[232:235], v[192:195], a[168:171]
ds_read_b64_tr_b16 a[130:131], v8 offset:25600
v_mfma_f32_16x16x32_bf16 a[168:171], v[216:219], v[172:175], a[168:171]
ds_read_b64_tr_b16 a[132:133], v9 offset:24576
v_mfma_f32_16x16x32_bf16 a[184:187], v[144:147], v[104:107], a[184:187]
ds_read_b64_tr_b16 a[134:135], v9 offset:25600
v_mfma_f32_16x16x32_bf16 a[184:187], v[160:163], v[124:127], a[184:187]
v_mfma_f32_16x16x32_bf16 a[184:187], v[216:219], v[176:179], a[184:187]
ds_read_b64_tr_b16 v[136:137], v8 offset:32768
v_mfma_f32_16x16x32_bf16 a[184:187], v[232:235], v[196:199], a[184:187]
buffer_store_dwordx4 a[152:155], v51, s[16:19], s48 offen offset:0 sc1
v_mfma_f32_16x16x32_bf16 a[200:203], v[160:163], v[128:131], a[200:203]
ds_read_b64_tr_b16 v[138:139], v8 offset:33792
ds_read_b64_tr_b16 v[140:141], v9 offset:32768
v_mfma_f32_16x16x32_bf16 a[200:203], v[144:147], v[108:111], a[200:203]
ds_read_b64_tr_b16 v[142:143], v9 offset:33792
v_mfma_f32_16x16x32_bf16 a[200:203], v[232:235], v[200:203], a[200:203]
v_mfma_f32_16x16x32_bf16 a[200:203], v[216:219], v[180:183], a[200:203]
buffer_store_dwordx4 a[168:171], v51, s[16:19], s48 offen offset:2048 sc1
v_mfma_f32_16x16x32_bf16 a[216:219], v[144:147], v[112:115], a[216:219]
ds_read_b64_tr_b16 v[152:153], v8 offset:40960
ds_read_b64_tr_b16 v[154:155], v8 offset:41984
v_mfma_f32_16x16x32_bf16 a[216:219], v[160:163], v[132:135], a[216:219]
ds_read_b64_tr_b16 v[156:157], v9 offset:40960
v_mfma_f32_16x16x32_bf16 a[216:219], v[216:219], v[184:187], a[216:219]
ds_read_b64_tr_b16 v[158:159], v9 offset:41984
v_mfma_f32_16x16x32_bf16 a[216:219], v[232:235], v[204:207], a[216:219]
buffer_store_dwordx4 a[184:187], v95, s[16:19], s48 offen offset:0 sc1
v_mfma_f32_16x16x32_bf16 a[220:223], v[164:167], v[132:135], a[220:223]
ds_read_b64_tr_b16 v[208:209], v8 offset:49152
v_mfma_f32_16x16x32_bf16 a[220:223], v[148:151], v[112:115], a[220:223]
ds_read_b64_tr_b16 v[210:211], v8 offset:50176
v_mfma_f32_16x16x32_bf16 a[220:223], v[236:239], v[204:207], a[220:223]
ds_read_b64_tr_b16 v[212:213], v9 offset:49152
v_mfma_f32_16x16x32_bf16 a[220:223], v[220:223], v[184:187], a[220:223]
buffer_store_dwordx4 a[200:203], v95, s[16:19], s48 offen offset:2048 sc1
v_mfma_f32_16x16x32_bf16 a[204:207], v[148:151], v[108:111], a[204:207]
ds_read_b64_tr_b16 v[214:215], v9 offset:50176
v_mfma_f32_16x16x32_bf16 a[204:207], v[164:167], v[128:131], a[204:207]
ds_read_b64_tr_b16 v[224:225], v8 offset:57344
v_mfma_f32_16x16x32_bf16 a[204:207], v[220:223], v[180:183], a[204:207]
ds_read_b64_tr_b16 v[226:227], v8 offset:58368
v_mfma_f32_16x16x32_bf16 a[204:207], v[236:239], v[200:203], a[204:207]
buffer_store_dwordx4 a[216:219], v94, s[16:19], s48 offen offset:0 sc1
v_mfma_f32_16x16x32_bf16 a[188:191], v[164:167], v[124:127], a[188:191]
ds_read_b64_tr_b16 v[228:229], v9 offset:57344
ds_read_b64_tr_b16 v[230:231], v9 offset:58368
v_mfma_f32_16x16x32_bf16 a[188:191], v[148:151], v[104:107], a[188:191]
v_mfma_f32_16x16x32_bf16 a[188:191], v[236:239], v[196:199], a[188:191]
v_mfma_f32_16x16x32_bf16 a[188:191], v[220:223], v[176:179], a[188:191]
buffer_store_dwordx4 a[220:223], v94, s[16:19], s48 offen offset:1024 sc1
v_mfma_f32_16x16x32_bf16 a[172:175], v[148:151], v[100:103], a[172:175]
v_mfma_f32_16x16x32_bf16 a[172:175], v[164:167], v[120:123], a[172:175]
v_mfma_f32_16x16x32_bf16 a[172:175], v[220:223], v[172:175], a[172:175]
v_mfma_f32_16x16x32_bf16 a[172:175], v[236:239], v[192:195], a[172:175]
buffer_store_dwordx4 a[204:207], v95, s[16:19], s48 offen offset:3072 sc1
v_mfma_f32_16x16x32_bf16 a[156:159], v[164:167], v[116:119], a[156:159]
v_mfma_f32_16x16x32_bf16 a[156:159], v[148:151], v[96:99], a[156:159]
v_mfma_f32_16x16x32_bf16 a[156:159], v[236:239], v[188:191], a[156:159]
s_waitcnt lgkmcnt(0)
v_mfma_f32_16x16x32_bf16 a[156:159], v[220:223], v[168:171], a[156:159]
buffer_store_dwordx4 a[188:191], v95, s[16:19], s48 offen offset:1024 sc1
v_mfma_f32_16x16x32_bf16 a[144:147], a[112:115], a[72:75], a[144:147]
v_mfma_f32_16x16x32_bf16 a[144:147], a[128:131], a[92:95], a[144:147]
v_mfma_f32_16x16x32_bf16 a[160:163], a[128:131], a[96:99], a[160:163]
v_mfma_f32_16x16x32_bf16 a[160:163], a[112:115], a[76:79], a[160:163]
buffer_store_dwordx4 a[172:175], v51, s[16:19], s48 offen offset:3072 sc1
v_mfma_f32_16x16x32_bf16 a[176:179], a[112:115], a[80:83], a[176:179]
v_mfma_f32_16x16x32_bf16 a[176:179], a[128:131], a[100:103], a[176:179]
v_mfma_f32_16x16x32_bf16 a[192:195], a[128:131], a[104:107], a[192:195]
v_mfma_f32_16x16x32_bf16 a[192:195], a[112:115], a[84:87], a[192:195]
buffer_store_dwordx4 a[156:159], v51, s[16:19], s48 offen offset:1024 sc1
v_mfma_f32_16x16x32_bf16 a[208:211], a[112:115], a[88:91], a[208:211]
v_mfma_f32_16x16x32_bf16 a[208:211], a[128:131], a[108:111], a[208:211]
v_mfma_f32_16x16x32_bf16 a[212:215], a[132:135], a[108:111], a[212:215]
v_mfma_f32_16x16x32_bf16 a[212:215], a[116:119], a[88:91], a[212:215]
v_mfma_f32_16x16x32_bf16 a[196:199], a[116:119], a[84:87], a[196:199]
v_mfma_f32_16x16x32_bf16 a[196:199], a[132:135], a[104:107], a[196:199]
v_mfma_f32_16x16x32_bf16 a[180:183], a[132:135], a[100:103], a[180:183]
v_mfma_f32_16x16x32_bf16 a[180:183], a[116:119], a[80:83], a[180:183]
v_mfma_f32_16x16x32_bf16 a[164:167], a[116:119], a[76:79], a[164:167]
v_mfma_f32_16x16x32_bf16 a[164:167], a[132:135], a[96:99], a[164:167]
v_mfma_f32_16x16x32_bf16 a[148:151], a[132:135], a[92:95], a[148:151]
v_mfma_f32_16x16x32_bf16 a[148:151], a[116:119], a[72:75], a[148:151]
v_mfma_f32_16x16x32_bf16 a[144:147], v[136:139], v[96:99], a[144:147]
v_mfma_f32_16x16x32_bf16 a[144:147], v[152:155], v[116:119], a[144:147]
v_mfma_f32_16x16x32_bf16 a[160:163], v[152:155], v[120:123], a[160:163]
v_mfma_f32_16x16x32_bf16 a[160:163], v[136:139], v[100:103], a[160:163]
v_mfma_f32_16x16x32_bf16 a[176:179], v[136:139], v[104:107], a[176:179]
v_mfma_f32_16x16x32_bf16 a[176:179], v[152:155], v[124:127], a[176:179]
v_mfma_f32_16x16x32_bf16 a[192:195], v[152:155], v[128:131], a[192:195]
v_mfma_f32_16x16x32_bf16 a[192:195], v[136:139], v[108:111], a[192:195]
v_mfma_f32_16x16x32_bf16 a[208:211], v[136:139], v[112:115], a[208:211]
v_mfma_f32_16x16x32_bf16 a[208:211], v[152:155], v[132:135], a[208:211]
v_mfma_f32_16x16x32_bf16 a[212:215], v[156:159], v[132:135], a[212:215]
v_mfma_f32_16x16x32_bf16 a[212:215], v[140:143], v[112:115], a[212:215]
v_mfma_f32_16x16x32_bf16 a[196:199], v[140:143], v[108:111], a[196:199]
v_mfma_f32_16x16x32_bf16 a[196:199], v[156:159], v[128:131], a[196:199]
v_mfma_f32_16x16x32_bf16 a[180:183], v[156:159], v[124:127], a[180:183]
v_mfma_f32_16x16x32_bf16 a[180:183], v[140:143], v[104:107], a[180:183]
v_mfma_f32_16x16x32_bf16 a[164:167], v[140:143], v[100:103], a[164:167]
v_mfma_f32_16x16x32_bf16 a[164:167], v[156:159], v[120:123], a[164:167]
v_mfma_f32_16x16x32_bf16 a[148:151], v[156:159], v[116:119], a[148:151]
v_mfma_f32_16x16x32_bf16 a[148:151], v[140:143], v[96:99], a[148:151]
v_mfma_f32_16x16x32_bf16 a[144:147], v[208:211], v[168:171], a[144:147]
v_mfma_f32_16x16x32_bf16 a[144:147], v[224:227], v[188:191], a[144:147]
v_mfma_f32_16x16x32_bf16 a[160:163], v[224:227], v[192:195], a[160:163]
v_mfma_f32_16x16x32_bf16 a[160:163], v[208:211], v[172:175], a[160:163]
v_mfma_f32_16x16x32_bf16 a[176:179], v[208:211], v[176:179], a[176:179]
v_mfma_f32_16x16x32_bf16 a[176:179], v[224:227], v[196:199], a[176:179]
v_mfma_f32_16x16x32_bf16 a[192:195], v[224:227], v[200:203], a[192:195]
v_mfma_f32_16x16x32_bf16 a[192:195], v[208:211], v[180:183], a[192:195]
v_mfma_f32_16x16x32_bf16 a[208:211], v[208:211], v[184:187], a[208:211]
v_mfma_f32_16x16x32_bf16 a[208:211], v[224:227], v[204:207], a[208:211]
v_mfma_f32_16x16x32_bf16 a[212:215], v[228:231], v[204:207], a[212:215]
v_mfma_f32_16x16x32_bf16 a[212:215], v[212:215], v[184:187], a[212:215]
v_mfma_f32_16x16x32_bf16 a[196:199], v[212:215], v[180:183], a[196:199]
v_mfma_f32_16x16x32_bf16 a[196:199], v[228:231], v[200:203], a[196:199]
v_mfma_f32_16x16x32_bf16 a[180:183], v[228:231], v[196:199], a[180:183]
v_mfma_f32_16x16x32_bf16 a[180:183], v[212:215], v[176:179], a[180:183]
v_mfma_f32_16x16x32_bf16 a[164:167], v[212:215], v[172:175], a[164:167]
v_mfma_f32_16x16x32_bf16 a[164:167], v[228:231], v[192:195], a[164:167]
v_mfma_f32_16x16x32_bf16 a[148:151], v[228:231], v[188:191], a[148:151]
v_mfma_f32_16x16x32_bf16 a[148:151], v[212:215], v[168:171], a[148:151]
s_waitcnt vmcnt(0)
buffer_store_dword v12, off, s[16:19], s51 offset:32 sc1
s_mov_b32 s43, 0
L_pl3:
buffer_load_dword v13, off, s[16:19], s50 offset:32 sc1
s_add_u32 s43, s43, 1
s_waitcnt vmcnt(0)
v_readfirstlane_b32 s42, v13
s_cmp_ge_u32 s43, 16777216
s_cbranch_scc1 L_pld3
s_cmp_lt_u32 s42, 1
s_cbranch_scc1 L_pl3
L_pld3:
buffer_load_dwordx4 v[96:99], v51, s[16:19], s49 offen offset:0 sc1
buffer_load_dwordx4 v[100:103], v51, s[16:19], s49 offen offset:1024 sc1
buffer_load_dwordx4 v[104:107], v51, s[16:19], s49 offen offset:2048 sc1
buffer_load_dwordx4 v[108:111], v51, s[16:19], s49 offen offset:3072 sc1
buffer_load_dwordx4 v[112:115], v95, s[16:19], s49 offen offset:0 sc1
buffer_load_dwordx4 v[116:119], v95, s[16:19], s49 offen offset:1024 sc1
buffer_load_dwordx4 v[120:123], v95, s[16:19], s49 offen offset:2048 sc1
buffer_load_dwordx4 v[124:127], v95, s[16:19], s49 offen offset:3072 sc1
buffer_load_dwordx4 v[128:131], v94, s[16:19], s49 offen offset:0 sc1
buffer_load_dwordx4 v[132:135], v94, s[16:19], s49 offen offset:1024 sc1
v_accvgpr_read_b32 v176, a144
v_accvgpr_read_b32 v177, a145
v_accvgpr_read_b32 v178, a146
v_accvgpr_read_b32 v179, a147
v_accvgpr_read_b32 v180, a148
v_accvgpr_read_b32 v181, a149
v_accvgpr_read_b32 v182, a150
v_accvgpr_read_b32 v183, a151
v_accvgpr_read_b32 v184, a160
v_accvgpr_read_b32 v185, a161
v_accvgpr_read_b32 v186, a162
v_accvgpr_read_b32 v187, a163
v_accvgpr_read_b32 v188, a164
v_accvgpr_read_b32 v189, a165
v_accvgpr_read_b32 v190, a166
v_accvgpr_read_b32 v191, a167
v_accvgpr_read_b32 v192, a176
v_accvgpr_read_b32 v193, a177
v_accvgpr_read_b32 v194, a178
v_accvgpr_read_b32 v195, a179
v_accvgpr_read_b32 v196, a180
v_accvgpr_read_b32 v197, a181
v_accvgpr_read_b32 v198, a182
v_accvgpr_read_b32 v199, a183
v_accvgpr_read_b32 v200, a192
v_accvgpr_read_b32 v201, a193
v_accvgpr_read_b32 v202, a194
v_accvgpr_read_b32 v203, a195
v_accvgpr_read_b32 v204, a196
v_accvgpr_read_b32 v205, a197
v_accvgpr_read_b32 v206, a198
v_accvgpr_read_b32 v207, a199
v_accvgpr_read_b32 v208, a208
v_accvgpr_read_b32 v209, a209
v_accvgpr_read_b32 v210, a210
v_accvgpr_read_b32 v211, a211
v_accvgpr_read_b32 v212, a212
v_accvgpr_read_b32 v213, a213
v_accvgpr_read_b32 v214, a214
v_accvgpr_read_b32 v215, a215
s_mov_b32 s31, 0
s_waitcnt vmcnt(8)
v_pk_add_f32 v[176:177], v[176:177], v[96:97]
v_pk_add_f32 v[178:179], v[178:179], v[98:99]
v_pk_add_f32 v[180:181], v[180:181], v[100:101]
v_pk_add_f32 v[182:183], v[182:183], v[102:103]
v_cvt_pk_bf16_f32 v56, v176, v177
v_cvt_pk_bf16_f32 v57, v178, v179
v_cvt_pk_bf16_f32 v58, v180, v181
v_cvt_pk_bf16_f32 v59, v182, v183
s_nop 1
v_permlane16_swap_b32 v56, v58
v_permlane16_swap_b32 v57, v59
buffer_store_dwordx4 v[56:59], v1, s[12:15], s31 offen sc1
s_add_u32 s31, s31, 0x10000
s_waitcnt vmcnt(7)
v_pk_add_f32 v[184:185], v[184:185], v[104:105]
v_pk_add_f32 v[186:187], v[186:187], v[106:107]
v_pk_add_f32 v[188:189], v[188:189], v[108:109]
v_pk_add_f32 v[190:191], v[190:191], v[110:111]
v_cvt_pk_bf16_f32 v60, v184, v185
v_cvt_pk_bf16_f32 v61, v186, v187
v_cvt_pk_bf16_f32 v62, v188, v189
v_cvt_pk_bf16_f32 v63, v190, v191
s_nop 1
v_permlane16_swap_b32 v60, v62
v_permlane16_swap_b32 v61, v63
buffer_store_dwordx4 v[60:63], v1, s[12:15], s31 offen sc1
s_add_u32 s31, s31, 0x10000
s_waitcnt vmcnt(6)
v_pk_add_f32 v[192:193], v[192:193], v[112:113]
v_pk_add_f32 v[194:195], v[194:195], v[114:115]
v_pk_add_f32 v[196:197], v[196:197], v[116:117]
v_pk_add_f32 v[198:199], v[198:199], v[118:119]
v_cvt_pk_bf16_f32 v64, v192, v193
v_cvt_pk_bf16_f32 v65, v194, v195
v_cvt_pk_bf16_f32 v66, v196, v197
v_cvt_pk_bf16_f32 v67, v198, v199
s_nop 1
v_permlane16_swap_b32 v64, v66
v_permlane16_swap_b32 v65, v67
buffer_store_dwordx4 v[64:67], v1, s[12:15], s31 offen sc1
s_add_u32 s31, s31, 0x10000
s_waitcnt vmcnt(5)
v_pk_add_f32 v[200:201], v[200:201], v[120:121]
v_pk_add_f32 v[202:203], v[202:203], v[122:123]
v_pk_add_f32 v[204:205], v[204:205], v[124:125]
v_pk_add_f32 v[206:207], v[206:207], v[126:127]
v_cvt_pk_bf16_f32 v68, v200, v201
v_cvt_pk_bf16_f32 v69, v202, v203
v_cvt_pk_bf16_f32 v70, v204, v205
v_cvt_pk_bf16_f32 v71, v206, v207
s_nop 1
v_permlane16_swap_b32 v68, v70
v_permlane16_swap_b32 v69, v71
buffer_store_dwordx4 v[68:71], v1, s[12:15], s31 offen sc1
s_add_u32 s31, s31, 0x10000
s_waitcnt vmcnt(4)
v_pk_add_f32 v[208:209], v[208:209], v[128:129]
v_pk_add_f32 v[210:211], v[210:211], v[130:131]
v_pk_add_f32 v[212:213], v[212:213], v[132:133]
v_pk_add_f32 v[214:215], v[214:215], v[134:135]
v_cvt_pk_bf16_f32 v72, v208, v209
v_cvt_pk_bf16_f32 v73, v210, v211
v_cvt_pk_bf16_f32 v74, v212, v213
v_cvt_pk_bf16_f32 v75, v214, v215
s_nop 1
v_permlane16_swap_b32 v72, v74
v_permlane16_swap_b32 v73, v75
buffer_store_dwordx4 v[72:75], v1, s[12:15], s31 offen sc1
s_add_u32 s31, s31, 0x10000
L_end:
s_endpgm
L_fallback:
s_mov_b32 s36, 1
v_mov_b32 v240, 0xff800000
v_mov_b32 v244, 0xff800000
v_mov_b32 v248, 0xff800000
v_mov_b32 v252, 0xff800000
v_mov_b32 v92, 0xff800000
s_mov_b32 s65, 0
s_mov_b32 s46, 0
s_waitcnt vmcnt(0)
L_fb_loop:
s_barrier
s_mov_b32 m0, s62
s_add_u32 s28, s46, 65536
buffer_load_dwordx4 v47, s[12:15], s46 offen offset:0 nt lds
buffer_load_dwordx4 v48, s[12:15], s46 offen offset:1024 nt lds
buffer_load_dwordx4 v49, s[12:15], s46 offen offset:2048 nt lds
buffer_load_dwordx4 v50, s[12:15], s46 offen offset:3072 nt lds
s_add_u32 m0, s62, 4096
s_add_u32 s46, s46, 65536
buffer_load_dwordx4 v47, s[12:15], s46 offen offset:0 nt lds
buffer_load_dwordx4 v48, s[12:15], s46 offen offset:1024 nt lds
buffer_load_dwordx4 v49, s[12:15], s46 offen offset:2048 nt lds
buffer_load_dwordx4 v50, s[12:15], s46 offen offset:3072 nt lds
s_add_u32 m0, s62, 32768
s_or_b32 s46, s46, 0xfffdf0ff
s_add_u32 s46, s46, 1
s_and_b32 s46, s46, 0x20f00
s_waitcnt vmcnt(0)
s_barrier
ds_read_b128 v[176:179], v23 offset:0
ds_read_b128 v[180:183], v24 offset:0
ds_read_b128 v[184:187], v25 offset:0
ds_read_b128 v[188:191], v26 offset:0
ds_read_b128 v[192:195], v23 offset:4096
ds_read_b128 v[196:199], v24 offset:4096
ds_read_b128 v[200:203], v25 offset:4096
ds_read_b128 v[204:207], v26 offset:4096
s_waitcnt lgkmcnt(0)
v_mfma_f32_16x16x32_bf16 v[56:59], v[176:179], v[96:99], 0
v_mfma_f32_16x16x32_bf16 v[56:59], v[180:183], v[100:103], v[56:59]
v_mfma_f32_16x16x32_bf16 v[56:59], v[184:187], v[104:107], v[56:59]
v_mfma_f32_16x16x32_bf16 v[56:59], v[188:191], v[108:111], v[56:59]
v_mfma_f32_16x16x32_bf16 v[60:63], v[192:195], v[96:99], 0
v_mfma_f32_16x16x32_bf16 v[60:63], v[196:199], v[100:103], v[60:63]
v_mfma_f32_16x16x32_bf16 v[60:63], v[200:203], v[104:107], v[60:63]
v_mfma_f32_16x16x32_bf16 v[60:63], v[204:207], v[108:111], v[60:63]
s_nop 7
v_max3_f32 v240, v240, v56, v57
v_max3_f32 v240, v240, v58, v59
v_max3_f32 v240, v240, v60, v61
v_max3_f32 v240, v240, v62, v63
s_nop 1
v_mfma_f32_16x16x32_bf16 v[56:59], v[176:179], v[112:115], 0
v_mfma_f32_16x16x32_bf16 v[56:59], v[180:183], v[116:119], v[56:59]
v_mfma_f32_16x16x32_bf16 v[56:59], v[184:187], v[120:123], v[56:59]
v_mfma_f32_16x16x32_bf16 v[56:59], v[188:191], v[124:127], v[56:59]
v_mfma_f32_16x16x32_bf16 v[60:63], v[192:195], v[112:115], 0
v_mfma_f32_16x16x32_bf16 v[60:63], v[196:199], v[116:119], v[60:63]
v_mfma_f32_16x16x32_bf16 v[60:63], v[200:203], v[120:123], v[60:63]
v_mfma_f32_16x16x32_bf16 v[60:63], v[204:207], v[124:127], v[60:63]
s_nop 7
v_max3_f32 v244, v244, v56, v57
v_max3_f32 v244, v244, v58, v59
v_max3_f32 v244, v244, v60, v61
v_max3_f32 v244, v244, v62, v63
s_nop 1
v_mfma_f32_16x16x32_bf16 v[56:59], v[176:179], v[128:131], 0
v_mfma_f32_16x16x32_bf16 v[56:59], v[180:183], v[132:135], v[56:59]
v_mfma_f32_16x16x32_bf16 v[56:59], v[184:187], v[136:139], v[56:59]
v_mfma_f32_16x16x32_bf16 v[56:59], v[188:191], v[140:143], v[56:59]
v_mfma_f32_16x16x32_bf16 v[60:63], v[192:195], v[128:131], 0
v_mfma_f32_16x16x32_bf16 v[60:63], v[196:199], v[132:135], v[60:63]
v_mfma_f32_16x16x32_bf16 v[60:63], v[200:203], v[136:139], v[60:63]
v_mfma_f32_16x16x32_bf16 v[60:63], v[204:207], v[140:143], v[60:63]
s_nop 7
v_max3_f32 v248, v248, v56, v57
v_max3_f32 v248, v248, v58, v59
v_max3_f32 v248, v248, v60, v61
v_max3_f32 v248, v248, v62, v63
s_nop 1
v_mfma_f32_16x16x32_bf16 v[56:59], v[176:179], v[144:147], 0
v_mfma_f32_16x16x32_bf16 v[56:59], v[180:183], v[148:151], v[56:59]
v_mfma_f32_16x16x32_bf16 v[56:59], v[184:187], v[152:155], v[56:59]
v_mfma_f32_16x16x32_bf16 v[56:59], v[188:191], v[156:159], v[56:59]
v_mfma_f32_16x16x32_bf16 v[60:63], v[192:195], v[144:147], 0
v_mfma_f32_16x16x32_bf16 v[60:63], v[196:199], v[148:151], v[60:63]
v_mfma_f32_16x16x32_bf16 v[60:63], v[200:203], v[152:155], v[60:63]
v_mfma_f32_16x16x32_bf16 v[60:63], v[204:207], v[156:159], v[60:63]
s_nop 7
v_max3_f32 v252, v252, v56, v57
v_max3_f32 v252, v252, v58, v59
v_max3_f32 v252, v252, v60, v61
v_max3_f32 v252, v252, v62, v63
s_nop 1
v_mfma_f32_16x16x32_bf16 v[56:59], v[176:179], v[160:163], 0
v_mfma_f32_16x16x32_bf16 v[56:59], v[180:183], v[164:167], v[56:59]
v_mfma_f32_16x16x32_bf16 v[56:59], v[184:187], v[168:171], v[56:59]
v_mfma_f32_16x16x32_bf16 v[56:59], v[188:191], v[172:175], v[56:59]
v_mfma_f32_16x16x32_bf16 v[60:63], v[192:195], v[160:163], 0
v_mfma_f32_16x16x32_bf16 v[60:63], v[196:199], v[164:167], v[60:63]
v_mfma_f32_16x16x32_bf16 v[60:63], v[200:203], v[168:171], v[60:63]
v_mfma_f32_16x16x32_bf16 v[60:63], v[204:207], v[172:175], v[60:63]
s_nop 7
v_max3_f32 v92, v92, v56, v57
v_max3_f32 v92, v92, v58, v59
v_max3_f32 v92, v92, v60, v61
v_max3_f32 v92, v92, v62, v63
s_nop 1
s_add_u32 s65, s65, 1
s_cmp_lt_u32 s65, 32
s_cbranch_scc1 L_fb_loop
v_mov_b32 v241, v240
s_nop 1
v_permlane16_swap_b32 v240, v241
v_max_f32 v240, v240, v241
v_mov_b32 v241, v240
s_nop 1
v_permlane32_swap_b32 v240, v241
v_max_f32 v240, v240, v241
v_sub_f32 v240, 0, v240
v_mov_b32 v241, v240
v_mov_b32 v242, v240
v_mov_b32 v243, v240
v_mov_b32 v245, v244
s_nop 1
v_permlane16_swap_b32 v244, v245
v_max_f32 v244, v244, v245
v_mov_b32 v245, v244
s_nop 1
v_permlane32_swap_b32 v244, v245
v_max_f32 v244, v244, v245
v_sub_f32 v244, 0, v244
v_mov_b32 v245, v244
v_mov_b32 v246, v244
v_mov_b32 v247, v244
v_mov_b32 v249, v248
s_nop 1
v_permlane16_swap_b32 v248, v249
v_max_f32 v248, v248, v249
v_mov_b32 v249, v248
s_nop 1
v_permlane32_swap_b32 v248, v249
v_max_f32 v248, v248, v249
v_sub_f32 v248, 0, v248
v_mov_b32 v249, v248
v_mov_b32 v250, v248
v_mov_b32 v251, v248
v_mov_b32 v253, v252
s_nop 1
v_permlane16_swap_b32 v252, v253
v_max_f32 v252, v252, v253
v_mov_b32 v253, v252
s_nop 1
v_permlane32_swap_b32 v252, v253
v_max_f32 v252, v252, v253
v_sub_f32 v252, 0, v252
v_mov_b32 v253, v252
v_mov_b32 v254, v252
v_mov_b32 v255, v252
v_mov_b32 v93, v92
s_nop 1
v_permlane16_swap_b32 v92, v93
v_max_f32 v92, v92, v93
v_mov_b32 v93, v92
s_nop 1
v_permlane32_swap_b32 v92, v93
v_max_f32 v92, v92, v93
v_sub_f32 v92, 0, v92
v_mov_b32 v93, v92
v_mov_b32 v94, v92
v_mov_b32 v95, v92
v_accvgpr_write_b32 a0, 0
v_accvgpr_write_b32 a1, 0
v_accvgpr_write_b32 a2, 0
v_accvgpr_write_b32 a3, 0
v_accvgpr_write_b32 a4, 0
v_accvgpr_write_b32 a5, 0
v_accvgpr_write_b32 a6, 0
v_accvgpr_write_b32 a7, 0
v_accvgpr_write_b32 a8, 0
v_accvgpr_write_b32 a9, 0
v_accvgpr_write_b32 a10, 0
v_accvgpr_write_b32 a11, 0
v_accvgpr_write_b32 a12, 0
v_accvgpr_write_b32 a13, 0
v_accvgpr_write_b32 a14, 0
v_accvgpr_write_b32 a15, 0
v_accvgpr_write_b32 a16, 0
v_accvgpr_write_b32 a17, 0
v_accvgpr_write_b32 a18, 0
v_accvgpr_write_b32 a19, 0
v_accvgpr_write_b32 a20, 0
v_accvgpr_write_b32 a21, 0
v_accvgpr_write_b32 a22, 0
v_accvgpr_write_b32 a23, 0
v_accvgpr_write_b32 a24, 0
v_accvgpr_write_b32 a25, 0
v_accvgpr_write_b32 a26, 0
v_accvgpr_write_b32 a27, 0
v_accvgpr_write_b32 a28, 0
v_accvgpr_write_b32 a29, 0
v_accvgpr_write_b32 a30, 0
v_accvgpr_write_b32 a31, 0
v_accvgpr_write_b32 a32, 0
v_accvgpr_write_b32 a33, 0
v_accvgpr_write_b32 a34, 0
v_accvgpr_write_b32 a35, 0
v_accvgpr_write_b32 a36, 0
v_accvgpr_write_b32 a37, 0
v_accvgpr_write_b32 a38, 0
v_accvgpr_write_b32 a39, 0
v_accvgpr_write_b32 a40, 0
v_accvgpr_write_b32 a41, 0
v_accvgpr_write_b32 a42, 0
v_accvgpr_write_b32 a43, 0
v_accvgpr_write_b32 a44, 0
v_accvgpr_write_b32 a45, 0
v_accvgpr_write_b32 a46, 0
v_accvgpr_write_b32 a47, 0
v_accvgpr_write_b32 a48, 0
v_accvgpr_write_b32 a49, 0
v_accvgpr_write_b32 a50, 0
v_accvgpr_write_b32 a51, 0
v_accvgpr_write_b32 a52, 0
v_accvgpr_write_b32 a53, 0
v_accvgpr_write_b32 a54, 0
v_accvgpr_write_b32 a55, 0
v_accvgpr_write_b32 a56, 0
v_accvgpr_write_b32 a57, 0
v_accvgpr_write_b32 a58, 0
v_accvgpr_write_b32 a59, 0
v_accvgpr_write_b32 a60, 0
v_accvgpr_write_b32 a61, 0
v_accvgpr_write_b32 a62, 0
v_accvgpr_write_b32 a63, 0
v_accvgpr_write_b32 a64, 0
v_accvgpr_write_b32 a65, 0
v_accvgpr_write_b32 a66, 0
v_accvgpr_write_b32 a67, 0
v_accvgpr_write_b32 a68, 0
v_accvgpr_write_b32 a69, 0
v_accvgpr_write_b32 a70, 0
v_accvgpr_write_b32 a71, 0
v_accvgpr_write_b32 a72, 0
v_accvgpr_write_b32 a73, 0
v_accvgpr_write_b32 a74, 0
v_accvgpr_write_b32 a75, 0
v_accvgpr_write_b32 a76, 0
v_accvgpr_write_b32 a77, 0
v_accvgpr_write_b32 a78, 0
v_accvgpr_write_b32 a79, 0
v_accvgpr_write_b32 a80, 0
v_accvgpr_write_b32 a81, 0
v_accvgpr_write_b32 a82, 0
v_accvgpr_write_b32 a83, 0
v_accvgpr_write_b32 a84, 0
v_accvgpr_write_b32 a85, 0
v_accvgpr_write_b32 a86, 0
v_accvgpr_write_b32 a87, 0
v_accvgpr_write_b32 a88, 0
v_accvgpr_write_b32 a89, 0
v_accvgpr_write_b32 a90, 0
v_accvgpr_write_b32 a91, 0
v_accvgpr_write_b32 a92, 0
v_accvgpr_write_b32 a93, 0
v_accvgpr_write_b32 a94, 0
v_accvgpr_write_b32 a95, 0
v_accvgpr_write_b32 a96, 0
v_accvgpr_write_b32 a97, 0
v_accvgpr_write_b32 a98, 0
v_accvgpr_write_b32 a99, 0
v_accvgpr_write_b32 a100, 0
v_accvgpr_write_b32 a101, 0
v_accvgpr_write_b32 a102, 0
v_accvgpr_write_b32 a103, 0
v_accvgpr_write_b32 a104, 0
v_accvgpr_write_b32 a105, 0
v_accvgpr_write_b32 a106, 0
v_accvgpr_write_b32 a107, 0
v_accvgpr_write_b32 a108, 0
v_accvgpr_write_b32 a109, 0
v_accvgpr_write_b32 a110, 0
v_accvgpr_write_b32 a111, 0
v_accvgpr_write_b32 a112, 0
v_accvgpr_write_b32 a113, 0
v_accvgpr_write_b32 a114, 0
v_accvgpr_write_b32 a115, 0
v_accvgpr_write_b32 a116, 0
v_accvgpr_write_b32 a117, 0
v_accvgpr_write_b32 a118, 0
v_accvgpr_write_b32 a119, 0
v_accvgpr_write_b32 a120, 0
v_accvgpr_write_b32 a121, 0
v_accvgpr_write_b32 a122, 0
v_accvgpr_write_b32 a123, 0
v_accvgpr_write_b32 a124, 0
v_accvgpr_write_b32 a125, 0
v_accvgpr_write_b32 a126, 0
v_accvgpr_write_b32 a127, 0
v_accvgpr_write_b32 a128, 0
v_accvgpr_write_b32 a129, 0
v_accvgpr_write_b32 a130, 0
v_accvgpr_write_b32 a131, 0
v_accvgpr_write_b32 a132, 0
v_accvgpr_write_b32 a133, 0
v_accvgpr_write_b32 a134, 0
v_accvgpr_write_b32 a135, 0
v_accvgpr_write_b32 a136, 0
v_accvgpr_write_b32 a137, 0
v_accvgpr_write_b32 a138, 0
v_accvgpr_write_b32 a139, 0
v_accvgpr_write_b32 a140, 0
v_accvgpr_write_b32 a141, 0
v_accvgpr_write_b32 a142, 0
v_accvgpr_write_b32 a143, 0
v_accvgpr_write_b32 a144, 0
v_accvgpr_write_b32 a145, 0
v_accvgpr_write_b32 a146, 0
v_accvgpr_write_b32 a147, 0
v_accvgpr_write_b32 a148, 0
v_accvgpr_write_b32 a149, 0
v_accvgpr_write_b32 a150, 0
v_accvgpr_write_b32 a151, 0
v_accvgpr_write_b32 a152, 0
v_accvgpr_write_b32 a153, 0
v_accvgpr_write_b32 a154, 0
v_accvgpr_write_b32 a155, 0
v_accvgpr_write_b32 a156, 0
v_accvgpr_write_b32 a157, 0
v_accvgpr_write_b32 a158, 0
v_accvgpr_write_b32 a159, 0
v_accvgpr_write_b32 a160, 0
v_accvgpr_write_b32 a161, 0
v_accvgpr_write_b32 a162, 0
v_accvgpr_write_b32 a163, 0
v_accvgpr_write_b32 a164, 0
v_accvgpr_write_b32 a165, 0
v_accvgpr_write_b32 a166, 0
v_accvgpr_write_b32 a167, 0
v_accvgpr_write_b32 a168, 0
v_accvgpr_write_b32 a169, 0
v_accvgpr_write_b32 a170, 0
v_accvgpr_write_b32 a171, 0
v_accvgpr_write_b32 a172, 0
v_accvgpr_write_b32 a173, 0
v_accvgpr_write_b32 a174, 0
v_accvgpr_write_b32 a175, 0
v_accvgpr_write_b32 a176, 0
v_accvgpr_write_b32 a177, 0
v_accvgpr_write_b32 a178, 0
v_accvgpr_write_b32 a179, 0
v_cmp_eq_u32 vcc, 0, v52
v_mov_b32 v89, 0x3f803f80
s_nop 0
v_cndmask_b32 v88, 0, v89, vcc
v_mov_b32 v89, v88
v_mov_b32 v90, v88
v_mov_b32 v91, v88
v_mov_b32 v80, 0xff800000
v_mov_b32 v81, 0xff800000
v_mov_b32 v82, 0xff800000
v_mov_b32 v83, 0xff800000
v_mov_b32 v84, 0xff800000
v_mov_b32 v85, 0xff800000
v_mov_b32 v86, 0xff800000
v_mov_b32 v87, 0xff800000
v_mov_b32 v72, 0
v_mov_b32 v73, 0
v_mov_b32 v74, 0
v_mov_b32 v75, 0
s_barrier
s_mov_b32 m0, s62
s_mov_b32 s46, s3
buffer_load_dwordx4 v47, s[12:15], s46 offen offset:0 nt lds
buffer_load_dwordx4 v48, s[12:15], s46 offen offset:1024 nt lds
buffer_load_dwordx4 v49, s[12:15], s46 offen offset:2048 nt lds
buffer_load_dwordx4 v50, s[12:15], s46 offen offset:3072 nt lds
s_add_u32 m0, s62, 4096
s_add_u32 s46, s46, 65536
buffer_load_dwordx4 v47, s[12:15], s46 offen offset:0 nt lds
buffer_load_dwordx4 v48, s[12:15], s46 offen offset:1024 nt lds
buffer_load_dwordx4 v49, s[12:15], s46 offen offset:2048 nt lds
buffer_load_dwordx4 v50, s[12:15], s46 offen offset:3072 nt lds
s_add_u32 m0, s62, 32768
s_or_b32 s46, s46, 0xfffdf0ff
s_add_u32 s46, s46, 1
s_and_b32 s46, s46, 0x20f00
buffer_load_dwordx4 v47, s[12:15], s46 offen offset:0 nt lds
buffer_load_dwordx4 v48, s[12:15], s46 offen offset:1024 nt lds
buffer_load_dwordx4 v49, s[12:15], s46 offen offset:2048 nt lds
buffer_load_dwordx4 v50, s[12:15], s46 offen offset:3072 nt lds
s_add_u32 m0, s62, 36864
s_add_u32 s46, s46, 65536
buffer_load_dwordx4 v47, s[12:15], s46 offen offset:0 nt lds
buffer_load_dwordx4 v48, s[12:15], s46 offen offset:1024 nt lds
buffer_load_dwordx4 v49, s[12:15], s46 offen offset:2048 nt lds
buffer_load_dwordx4 v50, s[12:15], s46 offen offset:3072 nt lds
s_add_u32 m0, s62, 65536
s_or_b32 s46, s46, 0xfffdf0ff
s_add_u32 s46, s46, 1
s_and_b32 s46, s46, 0x20f00
buffer_load_dwordx4 v47, s[12:15], s46 offen offset:0 nt lds
buffer_load_dwordx4 v48, s[12:15], s46 offen offset:1024 nt lds
s_waitcnt vmcnt(10)
s_barrier
ds_read_b128 v[176:179], v23 offset:0
ds_read_b128 v[180:183], v24 offset:0
ds_read_b128 v[184:187], v25 offset:0
ds_read_b128 v[188:191], v26 offset:0
ds_read_b128 v[192:195], v23 offset:4096
ds_read_b128 v[196:199], v24 offset:4096
ds_read_b128 v[200:203], v25 offset:4096
ds_read_b128 v[204:207], v26 offset:4096
s_branch L_attn_go
L_code_end:
s_endpgm
s_endpgm
s_endpgm
s_endpgm
s_endpgm
s_endpgm
s_endpgm
s_endpgm
s_endpgm
s_endpgm
s_endpgm
s_endpgm
s_endpgm
s_endpgm
s_endpgm
s_endpgm
s_endpgm
s_endpgm
s_endpgm
s_endpgm
s_endpgm
s_endpgm
s_endpgm
s_endpgm
s_endpgm
s_endpgm
s_endpgm
s_endpgm
s_endpgm
s_endpgm
s_endpgm
s_endpgm
s_endpgm
s_endpgm
s_endpgm
s_endpgm
s_endpgm
s_endpgm
s_endpgm
s_endpgm
s_endpgm
s_endpgm
s_endpgm
s_endpgm
s_endpgm
s_endpgm
s_endpgm
s_endpgm
s_endpgm
s_endpgm
s_endpgm
s_endpgm
s_endpgm
s_endpgm
s_endpgm
s_endpgm
s_endpgm
s_endpgm
s_endpgm
s_endpgm
s_endpgm
s_endpgm
s_endpgm
s_endpgm
.section .rodata,"a"
.p2align 6
.amdhsa_kernel concat_heads__mha_block_cached__gqa_block_cached__near_ridge_kernel
  .amdhsa_next_free_vgpr 512
  .amdhsa_next_free_sgpr 102
  .amdhsa_accum_offset 256
  .amdhsa_group_segment_fixed_size 0
  .amdhsa_kernarg_size 104
  .amdhsa_user_sgpr_count 2
  .amdhsa_user_sgpr_kernarg_segment_ptr 1
  .amdhsa_system_sgpr_workgroup_id_x 1
.end_amdhsa_kernel
.text
```
